```python
import torch

def _softmax(x, axis=-1):
    return torch.softmax(x, dim=axis)
def _gelu(x):
    return torch.nn.functional.gelu(x, approximate="tanh")
def _silu(x):
    return torch.nn.functional.silu(x)
def _sigmoid(x):
    return torch.sigmoid(x)
def _layernorm(x, axis=-1, eps=1e-5):
    m = x.mean(dim=axis, keepdim=True)
    v = x.var(dim=axis, keepdim=True, unbiased=False)
    return (x - m) / torch.sqrt(v + eps)
def _scatter_add(tgt, idx, src, axis=0):
    return tgt.clone().index_add_(axis, idx, src)
def _segment_sum(src, seg, n):
    out = torch.zeros((n,) + src.shape[1:], dtype=src.dtype)
    return out.index_add_(0, seg, src)
def _pad(x, pw):
    flat = tuple(v for pair in reversed(pw) for v in pair)
    return torch.nn.functional.pad(x, flat)

kernel_name = 'concat_heads__mha_block__softmax_full_mha__prompt'

def setup_inputs():

    _w = (lambda a: (lambda t: t.to(torch.bfloat16) if t.is_floating_point() else t)(torch.as_tensor(a)))
    def _A_setup():
        B, S, D, H = 1, 2048, 640, 32
        return {
            "x": _w((lambda *s: torch.randn(*s, dtype=torch.bfloat16) * 0.2)(B, S, D)),
            "wqkv": _w((lambda *s: torch.randn(*s, dtype=torch.bfloat16) * 0.2)(D, 3 * D)),
            "wo": _w((lambda *s: torch.randn(*s, dtype=torch.bfloat16) * 0.05)(D, D)),
        }
    _A_in = _A_setup()

    def _B_setup():
        B, S, D = 1, 2048, 640
        return {
            "x": _w((lambda *s: torch.randn(*s, dtype=torch.bfloat16) * 0.2)(B, S, D)),
            "wqkv": _w((lambda *s: torch.randn(*s, dtype=torch.bfloat16) * 0.2)(D, 3 * D)),
            "wo": _w((lambda *s: torch.randn(*s, dtype=torch.bfloat16) * 0.05)(D, D)),
        }
    _B_in = _B_setup()

    return {
        "A_x": _A_in["x"],
        "A_wqkv": _A_in["wqkv"],
        "A_wo": _A_in["wo"],
        "B_x": _B_in["x"],
        "B_wqkv": _B_in["wqkv"],
        "B_wo": _B_in["wo"],
    }

def reference(A_x, A_wqkv, A_wo, B_x, B_wqkv, B_wo):
    def _A_ref(x, wqkv, wo):
        B, S, D = x.shape
        H = 32
        Dh = D // H
        qkv = (lambda x, *d: x.permute(*d))((x @ wqkv).reshape(B, S, 3, H, Dh), 2, 0, 3, 1, 4)
        q, k, v = qkv[0], qkv[1], qkv[2]
        scores = torch.einsum("bhqd,bhkd->bhqk", q, k) * (Dh ** -0.5)
        p = _softmax(scores, axis=-1)
        o = torch.einsum("bhqk,bhkd->bhqd", p, v)
        return (lambda x, *d: x.permute(*d))(o, 0, 2, 1, 3).reshape(B, S, D) @ wo

    def _B_ref(x, wqkv, wo):
        B, S, D = x.shape
        H = 32; Dh = D // H
        qkv = (lambda x, *d: x.permute(*d))((x @ wqkv).reshape(B, S, 3, H, Dh), 2, 0, 3, 1, 4)
        q, k, v = qkv[0], qkv[1], qkv[2]
        scale = Dh ** -0.5
        scores = torch.einsum("bhqd,bhkd->bhqk", q, k) * scale
        p = _softmax(scores, axis=-1)
        o = torch.einsum("bhqk,bhkd->bhqd", p, v)
        return (lambda x, *d: x.permute(*d))(o, 0, 2, 1, 3).reshape(B, S, D) @ wo

    a = _A_ref(A_x, A_wqkv, A_wo)
    b = _B_ref(B_x, B_wqkv, B_wo)
    return torch.concatenate([a, b], axis=-1)
```

```asm
; @launch grid=(256,1,1) block=(512,1,1) lds=163840
.amdgcn_target "amdgcn-amd-amdhsa--gfx950"
.text
.globl concat_heads__mha_block__softmax_full_mha__prompt_kernel
.p2align 8
.type concat_heads__mha_block__softmax_full_mha__prompt_kernel,@function
concat_heads__mha_block__softmax_full_mha__prompt_kernel:
    s_load_dwordx16 s[16:31], s[0:1], 0
    s_load_dwordx2 s[32:33], s[0:1], 64
    s_cmp_ge_u32 s2, 256
    s_cbranch_scc1 L_end_1
    s_getpc_b64 s[4:5]
Lpc_concat_heads__mha_block__softmax_full_mha__prompt_kernel:
    s_mov_b32 s6, Lcode_end-Lpc_concat_heads__mha_block__softmax_full_mha__prompt_kernel
    s_mov_b32 s7, 0x00020000
    v_and_b32 v1, 7, v0
    s_and_b32 s3, s2, 0xf8
    v_or_b32 v1, s3, v1
    v_lshlrev_b32 v1, 7, v1
    buffer_load_dword v159, v1, s[4:7], 0 offen
    s_mov_b64 exec, -1
    v_lshrrev_b32 v1, 6, v0
    v_and_b32 v255, 63, v0
    v_readfirstlane_b32 s47, v1
    s_and_b32 s50, s2, 7
    s_lshr_b32 s51, s2, 3
    s_lshr_b32 s44, s50, 2
    s_and_b32 s50, s50, 3
    s_lshr_b32 s52, s51, 3
    s_lshl2_add_u32 s45, s50, s52
    s_and_b32 s46, s51, 7
    s_mov_b32 s49, 0x88553300
    s_cmp_eq_u32 s52, 1
    s_cselect_b32 s49, 0x885533, s49
    s_cmp_eq_u32 s52, 2
    s_cselect_b32 s49, 0x33008855, s49
    s_cmp_eq_u32 s52, 3
    s_cselect_b32 s49, 0x55330088, s49
    s_lshl_b32 s51, s46, 2
    s_lshr_b32 s49, s49, s51
    s_and_b32 s49, s49, 15
    s_mul_i32 s50, s50, 2
    s_add_u32 s49, s49, s50
    s_cmp_ge_u32 s49, 10
    s_cselect_b32 s50, 10, 0
    s_sub_u32 s49, s49, s50
    s_and_b32 s61, s47, 3
    s_lshr_b32 s58, s47, 2
    s_cbranch_scc0 L_cons_2
    s_setprio 3
    v_lshrrev_b32 v200, 4, v255
    v_xor_b32 v200, v200, v255
    v_and_b32 v200, 7, v200
    v_lshrrev_b32 v201, 3, v255
    v_mul_u32_u24 v201, 1280, v201
    v_lshl_add_u32 v160, v200, 4, v201
    v_xor_b32 v161, 64, v160
    v_add_u32 v161, 9216, v161
    v_add_u32 v162, 18432, v160
    v_add_u32 v163, 18432, v161
    s_lshl_b32 s56, s61, 12
    s_mul_i32 s57, s61, 5120
    s_add_u32 s57, s57, 16384
    s_lshl2_add_u32 s50, s45, s61
    s_mul_i32 s50, s50, 40960
    s_mul_i32 s35, s46, 320
    s_mul_i32 s51, s61, 61440
    s_add_u32 s35, s35, s51
    s_add_u32 s34, s35, 1280
    s_mov_b32 s60, s49
    s_waitcnt lgkmcnt(0)
    s_cmp_eq_u32 s44, 0
    s_cselect_b64 s[16:17], s[16:17], s[22:23]
    s_cselect_b64 s[18:19], s[18:19], s[24:25]
    s_cselect_b64 s[20:21], s[20:21], s[26:27]
    s_add_u32 s4, s16, s50
    s_addc_u32 s5, s17, 0
    s_mov_b32 s6, 40960
    s_mov_b32 s7, 0x00020000
    s_mov_b64 s[8:9], s[18:19]
    s_mov_b32 s10, 2457600
    s_mov_b32 s11, 0x00020000
    s_add_u32 m0, s56, 0
    s_lshl_b32 s54, s49, 7
    buffer_load_dwordx4 v160, s[4:7], s54 offen offset:0 lds
    buffer_load_dwordx4 v161, s[4:7], s54 offen offset:1024 lds
    buffer_load_dwordx4 v162, s[4:7], s54 offen offset:2048 lds
    buffer_load_dwordx4 v163, s[4:7], s54 offen offset:3072 lds
    s_movk_i32 s52, 3277
    s_movk_i32 s51, 3520
    v_lshlrev_b32 v200, 4, v255
    v_mul_u32_u24 v201, s52, v255
    v_lshrrev_b32 v202, 16, v201
    v_mad_u32_u24 v164, v202, s51, v200
    v_add_u32 v201, 209728, v201
    v_lshrrev_b32 v202, 16, v201
    v_mad_u32_u24 v165, v202, s51, v200
    v_add_u32 v201, 209728, v201
    v_lshrrev_b32 v202, 16, v201
    v_mad_u32_u24 v166, v202, s51, v200
    v_subrev_u32 v203, 6554, v201
    v_lshrrev_b32 v203, 16, v203
    v_sub_u32 v203, v202, v203
    v_mad_u32_u24 v203, v203, 10, -1
    v_lshrrev_b32 v202, 3, v202
    v_mul_i32_i24 v203, v203, v202
    v_lshl_add_u32 v166, v203, 5, v166
    v_add_u32 v201, 209728, v201
    v_lshrrev_b32 v202, 16, v201
    v_mad_u32_u24 v167, v202, s51, v200
    v_subrev_u32 v203, 6554, v201
    v_lshrrev_b32 v203, 16, v203
    v_sub_u32 v203, v202, v203
    v_mad_u32_u24 v203, v203, 10, -1
    v_lshl_add_u32 v167, v203, 5, v167
    v_add_u32 v201, 209728, v201
    v_lshrrev_b32 v202, 16, v201
    v_mad_u32_u24 v168, v202, s51, v200
    v_subrev_u32 v203, 6554, v201
    v_lshrrev_b32 v203, 16, v203
    v_sub_u32 v203, v202, v203
    v_mad_u32_u24 v203, v203, 10, -1
    v_lshl_add_u32 v168, v203, 5, v168
    v_add_u32 v168, 4096, v168
    s_mul_i32 s55, s49, 245760
    s_add_u32 m0, s57, 0
    s_add_u32 s55, s55, s34
    buffer_load_dwordx4 v164, s[8:11], s55 offen offset:0 lds
    buffer_load_dwordx4 v165, s[8:11], s55 offen offset:1024 lds
    buffer_load_dwordx4 v166, s[8:11], s55 offen offset:2048 lds
    buffer_load_dwordx4 v167, s[8:11], s55 offen offset:3072 lds
    s_add_u32 m0, s57, 4096
    s_add_u32 s49, s49, 1
    buffer_load_dwordx4 v168, s[8:11], s55 offen lds
    s_cmp_eq_u32 s49, 10
    s_cselect_b32 s49, 0, s49
    s_lshl_b32 s50, s44, 7
    s_add_u32 s50, s50, 18350080
    s_load_dword s48, s[32:33], s50
    s_add_u32 s36, s32, 16777216
    s_addc_u32 s37, s33, 0
    s_mov_b32 s38, 1576960
    s_mov_b32 s39, 0x00020000
    s_lshl_b32 s51, s61, 12
    v_and_b32 v200, 15, v255
    v_lshrrev_b32 v201, 1, v200
    v_lshrrev_b32 v202, 4, v255
    v_xor_b32 v201, v201, v202
    v_lshl_add_u32 v200, v200, 7, s51
    v_lshl_add_u32 v210, v201, 4, v200
    v_xor_b32 v211, 64, v210
    v_and_b32 v200, 15, v255
    v_lshlrev_b32 v200, 2, v200
    v_add_u32 v200, 163712, v200
    v_mov_b32 v201, 0
    ds_write_b32 v200, v201
    s_add_u32 m0, s56, 36864
    s_lshl_b32 s54, s49, 7
    buffer_load_dwordx4 v160, s[4:7], s54 offen offset:0 lds
    buffer_load_dwordx4 v161, s[4:7], s54 offen offset:1024 lds
    buffer_load_dwordx4 v162, s[4:7], s54 offen offset:2048 lds
    buffer_load_dwordx4 v163, s[4:7], s54 offen offset:3072 lds
    s_mul_i32 s55, s49, 245760
    s_add_u32 m0, s57, 36864
    s_add_u32 s55, s55, s34
    buffer_load_dwordx4 v164, s[8:11], s55 offen offset:0 lds
    buffer_load_dwordx4 v165, s[8:11], s55 offen offset:1024 lds
    buffer_load_dwordx4 v166, s[8:11], s55 offen offset:2048 lds
    buffer_load_dwordx4 v167, s[8:11], s55 offen offset:3072 lds
    s_add_u32 m0, s57, 40960
    s_add_u32 s49, s49, 1
    buffer_load_dwordx4 v168, s[8:11], s55 offen lds
    s_cmp_eq_u32 s49, 10
    s_cselect_b32 s49, 0, s49
    s_setprio 0
    s_waitcnt lgkmcnt(0)
    s_mul_i32 s48, s48, 0x9E3779B1
    s_add_u32 s48, s48, 0x7F4A7C15
    s_waitcnt vmcnt(9)
    s_barrier
    s_add_u32 m0, s56, 73728
    s_lshl_b32 s54, s49, 7
    buffer_load_dwordx4 v160, s[4:7], s54 offen offset:0 lds
    buffer_load_dwordx4 v161, s[4:7], s54 offen offset:1024 lds
    buffer_load_dwordx4 v162, s[4:7], s54 offen offset:2048 lds
    buffer_load_dwordx4 v163, s[4:7], s54 offen offset:3072 lds
    s_mul_i32 s55, s49, 245760
    s_add_u32 m0, s57, 73728
    s_add_u32 s55, s55, s34
    buffer_load_dwordx4 v164, s[8:11], s55 offen offset:0 lds
    buffer_load_dwordx4 v165, s[8:11], s55 offen offset:1024 lds
    buffer_load_dwordx4 v166, s[8:11], s55 offen offset:2048 lds
    buffer_load_dwordx4 v167, s[8:11], s55 offen offset:3072 lds
    s_add_u32 m0, s57, 77824
    s_add_u32 s49, s49, 1
    buffer_load_dwordx4 v168, s[8:11], s55 offen lds
    s_cmp_eq_u32 s49, 10
    s_cselect_b32 s49, 0, s49
    ds_read_b128 v[0:3], v210 offset:0
    ds_read_b128 v[4:7], v210 offset:2048
    ds_read_b128 v[8:11], v211 offset:0
    ds_read_b128 v[12:15], v211 offset:2048
    s_movk_i32 s52, 3840
    v_mul_u32_u24 v212, 3277, v255
    v_lshrrev_b32 v212, 16, v212
    v_mad_i32_i24 v213, v212, -16, v255
    v_mad_i32_i24 v213, v212, -4, v213
    v_lshrrev_b32 v205, 3, v212
    v_mad_i32_i24 v213, v205, -2, v213
    v_add_u32 v205, 20, v213
    v_min_u32 v213, v213, v205
    v_cmp_lt_u32 vcc, 9, v213
    v_add_u32 v205, 16, v212
    v_subrev_u32 v204, 10, v213
    v_cndmask_b32 v212, v212, v205, vcc
    v_cndmask_b32 v213, v213, v204, vcc
    v_lshlrev_b32 v213, 4, v213
    v_mad_u32_u24 v251, v212, s52, v213
    v_add_u32 v200, 64, v255
    v_mul_u32_u24 v214, 3277, v200
    v_lshrrev_b32 v214, 16, v214
    v_mad_i32_i24 v215, v214, -16, v200
    v_mad_i32_i24 v215, v214, -4, v215
    v_lshrrev_b32 v205, 3, v214
    v_mad_i32_i24 v215, v205, -2, v215
    v_add_u32 v205, 20, v215
    v_min_u32 v215, v215, v205
    v_cmp_lt_u32 vcc, 9, v215
    v_add_u32 v205, 16, v214
    v_subrev_u32 v204, 10, v215
    v_cndmask_b32 v214, v214, v205, vcc
    v_cndmask_b32 v215, v215, v204, vcc
    v_lshlrev_b32 v215, 4, v215
    v_mad_u32_u24 v252, v214, s52, v215
    v_subrev_u32 v252, 1024, v252
    v_add_u32 v200, 128, v255
    v_mul_u32_u24 v216, 3277, v200
    v_lshrrev_b32 v216, 16, v216
    v_mad_i32_i24 v217, v216, -16, v200
    v_mad_i32_i24 v217, v216, -4, v217
    v_lshrrev_b32 v205, 3, v216
    v_mad_i32_i24 v217, v205, -2, v217
    v_add_u32 v205, 20, v217
    v_min_u32 v217, v217, v205
    v_cmp_lt_u32 vcc, 9, v217
    v_add_u32 v205, 16, v216
    v_subrev_u32 v204, 10, v217
    v_cndmask_b32 v216, v216, v205, vcc
    v_cndmask_b32 v217, v217, v204, vcc
    v_lshlrev_b32 v217, 4, v217
    v_mad_u32_u24 v253, v216, s52, v217
    v_subrev_u32 v253, 2048, v253
    v_add_u32 v200, 192, v255
    v_mul_u32_u24 v218, 3277, v200
    v_lshrrev_b32 v218, 16, v218
    v_mad_i32_i24 v219, v218, -16, v200
    v_mad_i32_i24 v219, v218, -4, v219
    v_lshrrev_b32 v205, 3, v218
    v_mad_i32_i24 v219, v205, -2, v219
    v_add_u32 v205, 20, v219
    v_min_u32 v219, v219, v205
    v_cmp_lt_u32 vcc, 9, v219
    v_add_u32 v205, 16, v218
    v_subrev_u32 v204, 10, v219
    v_cndmask_b32 v218, v218, v205, vcc
    v_cndmask_b32 v219, v219, v204, vcc
    v_lshlrev_b32 v219, 4, v219
    v_mad_u32_u24 v254, v218, s52, v219
    v_subrev_u32 v254, 3072, v254
    v_add_u32 v200, 256, v255
    v_mul_u32_u24 v220, 3277, v200
    v_lshrrev_b32 v220, 16, v220
    v_mad_i32_i24 v221, v220, -16, v200
    v_mad_i32_i24 v221, v220, -4, v221
    v_lshrrev_b32 v205, 3, v220
    v_mad_i32_i24 v221, v205, -2, v221
    v_add_u32 v205, 20, v221
    v_min_u32 v221, v221, v205
    v_cmp_lt_u32 vcc, 9, v221
    v_add_u32 v205, 16, v220
    v_subrev_u32 v204, 10, v221
    v_cndmask_b32 v220, v220, v205, vcc
    v_cndmask_b32 v221, v221, v204, vcc
    v_lshlrev_b32 v221, 4, v221
    v_mad_u32_u24 v245, v220, s52, v221
    s_lshl1_add_u32 s3, s60, s61
    s_mul_i32 s3, s3, 122880
    s_mul_i32 s50, s46, 160
    s_add_u32 s3, s3, s50
    s_waitcnt vmcnt(9) lgkmcnt(0)
    s_barrier
    s_add_u32 m0, s56, 110592
    s_lshl_b32 s54, s49, 7
    buffer_load_dwordx4 v160, s[4:7], s54 offen offset:0 lds
    buffer_load_dwordx4 v161, s[4:7], s54 offen offset:1024 lds
    buffer_load_dwordx4 v162, s[4:7], s54 offen offset:2048 lds
    buffer_load_dwordx4 v163, s[4:7], s54 offen offset:3072 lds
    s_mul_i32 s55, s49, 245760
    s_add_u32 m0, s57, 110592
    s_add_u32 s55, s55, s34
    buffer_load_dwordx4 v164, s[8:11], s55 offen offset:0 lds
    buffer_load_dwordx4 v165, s[8:11], s55 offen offset:1024 lds
    buffer_load_dwordx4 v166, s[8:11], s55 offen offset:2048 lds
    buffer_load_dwordx4 v167, s[8:11], s55 offen offset:3072 lds
    s_add_u32 m0, s57, 114688
    s_add_u32 s49, s49, 1
    buffer_load_dwordx4 v168, s[8:11], s55 offen lds
    s_cmp_eq_u32 s49, 10
    s_cselect_b32 s49, 0, s49
    ds_read_b128 v[16:19], v210 offset:36864
    ds_read_b128 v[20:23], v210 offset:38912
    ds_read_b128 v[24:27], v211 offset:36864
    ds_read_b128 v[28:31], v211 offset:38912
    v_bfe_u32 v200, v255, 2, 2
    v_lshrrev_b32 v201, 4, v255
    v_and_b32 v202, 1, v201
    v_lshl_add_u32 v200, v202, 3, v200
    v_mul_u32_u24 v200, 320, v200
    v_lshlrev_b32 v202, 5, v202
    v_lshrrev_b32 v201, 1, v201
    v_mul_u32_u24 v201, 160, v201
    v_add_u32 v202, v202, v201
    v_and_b32 v201, 3, v255
    v_mad_u32_u24 v202, v201, 40, v202
    v_add_u32 v201, 0, v202
    v_subrev_u32 v203, 320, v201
    v_min_u32 v201, v201, v203
    v_add_u32 v246, v201, v200
    v_add_u32 v201, 8, v202
    v_subrev_u32 v203, 320, v201
    v_min_u32 v201, v201, v203
    v_add_u32 v247, v201, v200
    v_add_u32 v201, 16, v202
    v_subrev_u32 v203, 320, v201
    v_min_u32 v201, v201, v203
    v_add_u32 v248, v201, v200
    v_add_u32 v201, 24, v202
    v_subrev_u32 v203, 320, v201
    v_min_u32 v201, v201, v203
    v_add_u32 v249, v201, v200
    v_add_u32 v201, 32, v202
    v_subrev_u32 v203, 320, v201
    v_min_u32 v201, v201, v203
    v_add_u32 v250, v201, v200
    s_waitcnt vmcnt(9) lgkmcnt(0)
    s_barrier
    s_add_u32 m0, s56, 0
    s_lshl_b32 s54, s49, 7
    buffer_load_dwordx4 v160, s[4:7], s54 offen offset:0 lds
    buffer_load_dwordx4 v161, s[4:7], s54 offen offset:1024 lds
    buffer_load_dwordx4 v162, s[4:7], s54 offen offset:2048 lds
    buffer_load_dwordx4 v163, s[4:7], s54 offen offset:3072 lds
    s_mul_i32 s55, s49, 245760
    s_add_u32 m0, s57, 0
    s_add_u32 s55, s55, s34
    buffer_load_dwordx4 v164, s[8:11], s55 offen offset:0 lds
    buffer_load_dwordx4 v165, s[8:11], s55 offen offset:1024 lds
    buffer_load_dwordx4 v166, s[8:11], s55 offen offset:2048 lds
    buffer_load_dwordx4 v167, s[8:11], s55 offen offset:3072 lds
    s_add_u32 m0, s57, 4096
    s_add_u32 s49, s49, 1
    buffer_load_dwordx4 v168, s[8:11], s55 offen lds
    s_cmp_eq_u32 s49, 10
    s_cselect_b32 s49, 0, s49
    v_add_u32 v210, 73728, v210
    v_add_u32 v211, 73728, v211
    ds_read_b128 v[32:35], v210 offset:0
    ds_read_b128 v[36:39], v210 offset:2048
    ds_read_b128 v[40:43], v211 offset:0
    ds_read_b128 v[44:47], v211 offset:2048
    s_lshl3_add_u32 s50, s44, s46
    s_lshl2_add_u32 s50, s50, s61
    s_mul_i32 s50, s50, 163840
    s_add_u32 s12, s32, s50
    s_addc_u32 s13, s33, 0
    s_mov_b32 s14, 163840
    s_mov_b32 s15, 0x00020000
    v_lshlrev_b32 v240, 4, v255
    v_lshlrev_b32 v241, 3, v255
    v_and_b32 v200, 31, v255
    v_lshrrev_b32 v201, 1, v200
    v_xor_b32 v201, v201, v200
    v_and_b32 v201, 4, v201
    v_mul_u32_u24 v201, 3, v201
    v_xor_b32 v201, v201, v200
    s_and_b32 s50, s61, 1
    s_lshl_b32 s50, s50, 2
    v_add_u32 v201, s50, v201
    v_subrev_u32 v202, 20, v201
    v_min_u32 v201, v201, v202
    v_lshrrev_b32 v202, 5, v255
    v_mul_u32_u24 v203, 320, v202
    v_lshl_add_u32 v242, v201, 4, v203
    v_add_u32 v242, 2560, v242
    s_and_b32 s59, s45, 12
    s_lshl1_add_u32 s59, s59, s58
    s_mul_i32 s59, s59, 5120
    s_mov_b32 s62, 0x000fffff
    s_mov_b32 s63, 0x000fffff
    s_lshl_b32 s35, s44, 9
    s_add_u32 s35, s35, 491520
    v_and_b32 v244, 3, v255
    v_lshlrev_b32 v244, 7, v244
    s_min_u32 s50, s47, 4
    s_lshl_b32 s51, s50, 6
    v_add_u32 v200, s51, v255
    v_mul_u32_u24 v201, 3277, v200
    v_lshrrev_b32 v201, 16, v201
    v_mad_i32_i24 v202, v201, -16, v200
    v_mad_i32_i24 v202, v201, -4, v202
    v_lshrrev_b32 v205, 3, v201
    v_mad_i32_i24 v202, v205, -2, v202
    v_add_u32 v205, 20, v202
    v_min_u32 v202, v202, v205
    s_movk_i32 s52, 1280
    v_cmp_lt_u32 vcc, 9, v202
    v_add_u32 v205, 16, v201
    v_subrev_u32 v204, 10, v202
    v_cndmask_b32 v201, v201, v205, vcc
    v_cndmask_b32 v202, v202, v204, vcc
    v_lshlrev_b32 v202, 4, v202
    v_mad_u32_u24 v243, v201, s52, v202
    s_waitcnt vmcnt(9) lgkmcnt(0)
    s_barrier
    s_add_u32 m0, s56, 36864
    s_lshl_b32 s54, s49, 7
    buffer_load_dwordx4 v160, s[4:7], s54 offen offset:0 lds
    buffer_load_dwordx4 v161, s[4:7], s54 offen offset:1024 lds
    buffer_load_dwordx4 v162, s[4:7], s54 offen offset:2048 lds
    buffer_load_dwordx4 v163, s[4:7], s54 offen offset:3072 lds
    s_mul_i32 s55, s49, 245760
    s_add_u32 m0, s57, 36864
    s_add_u32 s55, s55, s34
    buffer_load_dwordx4 v164, s[8:11], s55 offen offset:0 lds
    buffer_load_dwordx4 v165, s[8:11], s55 offen offset:1024 lds
    buffer_load_dwordx4 v166, s[8:11], s55 offen offset:2048 lds
    buffer_load_dwordx4 v167, s[8:11], s55 offen offset:3072 lds
    s_add_u32 m0, s57, 40960
    s_add_u32 s49, s49, 1
    buffer_load_dwordx4 v168, s[8:11], s55 offen lds
    s_cmp_eq_u32 s49, 10
    s_cselect_b32 s49, 0, s49
    ds_read_b128 v[48:51], v210 offset:36864
    ds_read_b128 v[52:55], v210 offset:38912
    ds_read_b128 v[56:59], v211 offset:36864
    ds_read_b128 v[60:63], v211 offset:38912
    s_waitcnt vmcnt(9) lgkmcnt(0)
    s_barrier
    s_add_u32 m0, s56, 73728
    s_lshl_b32 s54, s49, 7
    buffer_load_dwordx4 v160, s[4:7], s54 offen offset:0 lds
    buffer_load_dwordx4 v161, s[4:7], s54 offen offset:1024 lds
    buffer_load_dwordx4 v162, s[4:7], s54 offen offset:2048 lds
    buffer_load_dwordx4 v163, s[4:7], s54 offen offset:3072 lds
    s_mul_i32 s55, s49, 245760
    s_add_u32 m0, s57, 73728
    s_add_u32 s55, s55, s34
    buffer_load_dwordx4 v164, s[8:11], s55 offen offset:0 lds
    buffer_load_dwordx4 v165, s[8:11], s55 offen offset:1024 lds
    buffer_load_dwordx4 v166, s[8:11], s55 offen offset:2048 lds
    buffer_load_dwordx4 v167, s[8:11], s55 offen offset:3072 lds
    s_add_u32 m0, s57, 77824
    s_add_u32 s49, s49, 1
    buffer_load_dwordx4 v168, s[8:11], s55 offen lds
    s_cmp_eq_u32 s49, 10
    s_cselect_b32 s49, 0, s49
    v_subrev_u32 v210, 73728, v210
    v_subrev_u32 v211, 73728, v211
    ds_read_b128 v[64:67], v210 offset:0
    ds_read_b128 v[68:71], v210 offset:2048
    ds_read_b128 v[72:75], v211 offset:0
    ds_read_b128 v[76:79], v211 offset:2048
    s_waitcnt vmcnt(9) lgkmcnt(0)
    s_barrier
    s_add_u32 m0, s56, 110592
    s_lshl_b32 s54, s49, 7
    buffer_load_dwordx4 v160, s[4:7], s54 offen offset:0 lds
    buffer_load_dwordx4 v161, s[4:7], s54 offen offset:1024 lds
    buffer_load_dwordx4 v162, s[4:7], s54 offen offset:2048 lds
    buffer_load_dwordx4 v163, s[4:7], s54 offen offset:3072 lds
    s_mul_i32 s55, s49, 245760
    s_add_u32 m0, s57, 110592
    s_add_u32 s55, s55, s34
    buffer_load_dwordx4 v164, s[8:11], s55 offen offset:0 lds
    buffer_load_dwordx4 v165, s[8:11], s55 offen offset:1024 lds
    buffer_load_dwordx4 v166, s[8:11], s55 offen offset:2048 lds
    buffer_load_dwordx4 v167, s[8:11], s55 offen offset:3072 lds
    s_add_u32 m0, s57, 114688
    s_add_u32 s49, s49, 1
    buffer_load_dwordx4 v168, s[8:11], s55 offen lds
    s_cmp_eq_u32 s49, 10
    s_cselect_b32 s49, 0, s49
    ds_read_b128 v[80:83], v210 offset:36864
    ds_read_b128 v[84:87], v210 offset:38912
    ds_read_b128 v[88:91], v211 offset:36864
    ds_read_b128 v[92:95], v211 offset:38912
    s_waitcnt vmcnt(9) lgkmcnt(0)
    s_barrier
    s_add_u32 m0, s56, 0
    s_lshl_b32 s54, s49, 7
    buffer_load_dwordx4 v160, s[4:7], s54 offen offset:0 lds
    buffer_load_dwordx4 v161, s[4:7], s54 offen offset:1024 lds
    buffer_load_dwordx4 v162, s[4:7], s54 offen offset:2048 lds
    buffer_load_dwordx4 v163, s[4:7], s54 offen offset:3072 lds
    s_mul_i32 s55, s49, 245760
    s_add_u32 m0, s57, 0
    s_add_u32 s55, s55, s34
    buffer_load_dwordx4 v164, s[8:11], s55 offen offset:0 lds
    buffer_load_dwordx4 v165, s[8:11], s55 offen offset:1024 lds
    buffer_load_dwordx4 v166, s[8:11], s55 offen offset:2048 lds
    buffer_load_dwordx4 v167, s[8:11], s55 offen offset:3072 lds
    s_add_u32 m0, s57, 4096
    s_add_u32 s49, s49, 1
    buffer_load_dwordx4 v168, s[8:11], s55 offen lds
    s_cmp_eq_u32 s49, 10
    s_cselect_b32 s49, 0, s49
    v_add_u32 v210, 73728, v210
    v_add_u32 v211, 73728, v211
    ds_read_b128 v[96:99], v210 offset:0
    ds_read_b128 v[100:103], v210 offset:2048
    ds_read_b128 v[104:107], v211 offset:0
    ds_read_b128 v[108:111], v211 offset:2048
    s_waitcnt vmcnt(9) lgkmcnt(0)
    s_barrier
    s_add_u32 m0, s56, 36864
    s_lshl_b32 s54, s49, 7
    buffer_load_dwordx4 v160, s[4:7], s54 offen offset:0 lds
    buffer_load_dwordx4 v161, s[4:7], s54 offen offset:1024 lds
    buffer_load_dwordx4 v162, s[4:7], s54 offen offset:2048 lds
    buffer_load_dwordx4 v163, s[4:7], s54 offen offset:3072 lds
    s_mul_i32 s55, s49, 245760
    s_add_u32 m0, s57, 36864
    s_add_u32 s55, s55, s34
    buffer_load_dwordx4 v164, s[8:11], s55 offen offset:0 lds
    buffer_load_dwordx4 v165, s[8:11], s55 offen offset:1024 lds
    buffer_load_dwordx4 v166, s[8:11], s55 offen offset:2048 lds
    buffer_load_dwordx4 v167, s[8:11], s55 offen offset:3072 lds
    s_add_u32 m0, s57, 40960
    s_add_u32 s49, s49, 1
    buffer_load_dwordx4 v168, s[8:11], s55 offen lds
    s_cmp_eq_u32 s49, 10
    s_cselect_b32 s49, 0, s49
    ds_read_b128 v[112:115], v210 offset:36864
    ds_read_b128 v[116:119], v210 offset:38912
    ds_read_b128 v[120:123], v211 offset:36864
    ds_read_b128 v[124:127], v211 offset:38912
    s_waitcnt vmcnt(9) lgkmcnt(0)
    s_barrier
    s_add_u32 s55, s3, 0
    s_cmp_ge_u32 s55, 2457600
    s_cselect_b32 s51, 2457600, 0
    s_sub_u32 s55, s55, s51
    s_add_u32 s50, s57, 57344
    s_mov_b32 m0, s50
    s_add_u32 s50, s50, 4096
    buffer_load_dwordx4 v251, s[8:11], s55 offen offset:0 lds
    buffer_load_dwordx4 v252, s[8:11], s55 offen offset:1024 lds
    buffer_load_dwordx4 v253, s[8:11], s55 offen offset:2048 lds
    buffer_load_dwordx4 v254, s[8:11], s55 offen offset:3072 lds
    s_mov_b32 m0, s50
    s_nop 0
    buffer_load_dwordx4 v245, s[8:11], s55 offen lds
    v_subrev_u32 v210, 73728, v210
    v_subrev_u32 v211, 73728, v211
    ds_read_b128 v[128:131], v210 offset:0
    ds_read_b128 v[132:135], v210 offset:2048
    ds_read_b128 v[136:139], v211 offset:0
    ds_read_b128 v[140:143], v211 offset:2048
    s_waitcnt vmcnt(5) lgkmcnt(0)
    s_barrier
    s_add_u32 s55, s3, 491520
    s_cmp_ge_u32 s55, 2457600
    s_cselect_b32 s51, 2457600, 0
    s_sub_u32 s55, s55, s51
    s_add_u32 s50, s57, 77824
    s_cmp_eq_u32 s61, 3
    s_cselect_b32 s50, 147456, s50
    s_mov_b32 m0, s50
    s_add_u32 s50, s50, 4096
    buffer_load_dwordx4 v251, s[8:11], s55 offen offset:0 lds
    buffer_load_dwordx4 v252, s[8:11], s55 offen offset:1024 lds
    buffer_load_dwordx4 v253, s[8:11], s55 offen offset:2048 lds
    buffer_load_dwordx4 v254, s[8:11], s55 offen offset:3072 lds
    s_mov_b32 m0, s50
    s_nop 0
    buffer_load_dwordx4 v245, s[8:11], s55 offen lds
    ds_read_b128 v[144:147], v210 offset:36864
    ds_read_b128 v[148:151], v210 offset:38912
    ds_read_b128 v[152:155], v211 offset:36864
    ds_read_b128 v[156:159], v211 offset:38912
    s_waitcnt vmcnt(5) lgkmcnt(0)
    s_barrier
    s_setprio 1
    v_add_u32 v246, 57344, v246
    v_add_u32 v247, 57344, v247
    v_add_u32 v248, 57344, v248
    v_add_u32 v249, 57344, v249
    v_add_u32 v250, 57344, v250
    ds_read_b64_tr_b16 v[200:201], v246 offset:16384
    ds_read_b64_tr_b16 v[202:203], v246 offset:17664
    ds_read_b64_tr_b16 v[204:205], v247 offset:16384
    ds_read_b64_tr_b16 v[206:207], v247 offset:17664
    ds_read_b64_tr_b16 v[208:209], v248 offset:16384
    ds_read_b64_tr_b16 v[210:211], v248 offset:17664
    ds_read_b64_tr_b16 v[212:213], v249 offset:16384
    ds_read_b64_tr_b16 v[214:215], v249 offset:17664
    ds_read_b64_tr_b16 v[216:217], v250 offset:16384
    ds_read_b64_tr_b16 v[218:219], v250 offset:17664
    s_waitcnt lgkmcnt(6)
    v_mfma_f32_16x16x32_bf16 v[160:163], v[200:203], v[0:3], 0
    ds_read_b64_tr_b16 v[220:221], v246 offset:21504
    v_mfma_f32_16x16x32_bf16 v[180:183], v[200:203], v[4:7], 0
    ds_read_b64_tr_b16 v[222:223], v246 offset:22784
    s_add_u32 s55, s3, 983040
    s_cmp_ge_u32 s55, 2457600
    s_cselect_b32 s51, 2457600, 0
    s_sub_u32 s55, s55, s51
    s_add_u32 s50, s57, 94208
    s_mov_b32 m0, s50
    s_add_u32 s50, s50, 4096
    v_mfma_f32_16x16x32_bf16 v[164:167], v[204:207], v[0:3], 0
    ds_read_b64_tr_b16 v[224:225], v247 offset:21504
    v_mfma_f32_16x16x32_bf16 v[184:187], v[204:207], v[4:7], 0
    ds_read_b64_tr_b16 v[226:227], v247 offset:22784
    buffer_load_dwordx4 v251, s[8:11], s55 offen offset:0 lds
    s_waitcnt lgkmcnt(6)
    v_mfma_f32_16x16x32_bf16 v[168:171], v[208:211], v[0:3], 0
    ds_read_b64_tr_b16 v[228:229], v248 offset:21504
    v_mfma_f32_16x16x32_bf16 v[188:191], v[208:211], v[4:7], 0
    ds_read_b64_tr_b16 v[230:231], v248 offset:22784
    buffer_load_dwordx4 v252, s[8:11], s55 offen offset:1024 lds
    v_mfma_f32_16x16x32_bf16 v[172:175], v[212:215], v[0:3], 0
    ds_read_b64_tr_b16 v[232:233], v249 offset:21504
    v_mfma_f32_16x16x32_bf16 v[192:195], v[212:215], v[4:7], 0
    ds_read_b64_tr_b16 v[234:235], v249 offset:22784
    s_waitcnt lgkmcnt(8)
    v_mfma_f32_16x16x32_bf16 v[176:179], v[216:219], v[0:3], 0
    ds_read_b64_tr_b16 v[236:237], v250 offset:21504
    v_mfma_f32_16x16x32_bf16 v[196:199], v[216:219], v[4:7], 0
    ds_read_b64_tr_b16 v[238:239], v250 offset:22784
    s_lshl2_add_u32 s52, s61, 163712
    v_mov_b32 v4, s52
    v_and_b32 v5, 3, v255
    v_lshlrev_b32 v5, 2, v5
    v_add_u32 v5, 163712, v5
    v_mov_b32 v6, 1
    s_waitcnt lgkmcnt(6)
    v_mfma_f32_16x16x32_bf16 v[160:163], v[220:223], v[8:11], v[160:163]
    ds_read_b64_tr_b16 v[200:201], v246 offset:26624
    v_mfma_f32_16x16x32_bf16 v[180:183], v[220:223], v[12:15], v[180:183]
    ds_read_b64_tr_b16 v[202:203], v246 offset:27904
    s_waitcnt vmcnt(2)
    ds_write_b32 v4, v6 offset:0
    v_mfma_f32_16x16x32_bf16 v[164:167], v[224:227], v[8:11], v[164:167]
    ds_read_b64_tr_b16 v[204:205], v247 offset:26624
    v_mfma_f32_16x16x32_bf16 v[184:187], v[224:227], v[12:15], v[184:187]
    ds_read_b64_tr_b16 v[206:207], v247 offset:27904
    buffer_load_dwordx4 v253, s[8:11], s55 offen offset:2048 lds
    s_waitcnt lgkmcnt(6)
    v_mfma_f32_16x16x32_bf16 v[168:171], v[228:231], v[8:11], v[168:171]
    ds_read_b64_tr_b16 v[208:209], v248 offset:26624
    v_mfma_f32_16x16x32_bf16 v[188:191], v[228:231], v[12:15], v[188:191]
    ds_read_b64_tr_b16 v[210:211], v248 offset:27904
    buffer_load_dwordx4 v254, s[8:11], s55 offen offset:3072 lds
    v_mfma_f32_16x16x32_bf16 v[172:175], v[232:235], v[8:11], v[172:175]
    ds_read_b64_tr_b16 v[212:213], v249 offset:26624
    v_mfma_f32_16x16x32_bf16 v[192:195], v[232:235], v[12:15], v[192:195]
    ds_read_b64_tr_b16 v[214:215], v249 offset:27904
    s_waitcnt lgkmcnt(8)
    v_mfma_f32_16x16x32_bf16 v[176:179], v[236:239], v[8:11], v[176:179]
    ds_read_b64_tr_b16 v[216:217], v250 offset:26624
    v_mfma_f32_16x16x32_bf16 v[196:199], v[236:239], v[12:15], v[196:199]
    ds_read_b64_tr_b16 v[218:219], v250 offset:27904
    s_waitcnt lgkmcnt(6)
    v_mfma_f32_16x16x32_bf16 v[160:163], v[200:203], v[16:19], v[160:163]
    ds_read_b64_tr_b16 v[220:221], v246 offset:31744
    v_mfma_f32_16x16x32_bf16 v[180:183], v[200:203], v[20:23], v[180:183]
    ds_read_b64_tr_b16 v[222:223], v246 offset:33024
    ds_read_b32 v7, v5 offset:0
    v_mfma_f32_16x16x32_bf16 v[164:167], v[204:207], v[16:19], v[164:167]
    ds_read_b64_tr_b16 v[224:225], v247 offset:31744
    v_mfma_f32_16x16x32_bf16 v[184:187], v[204:207], v[20:23], v[184:187]
    ds_read_b64_tr_b16 v[226:227], v247 offset:33024
    s_mov_b32 m0, s50
    s_nop 0
    buffer_load_dwordx4 v245, s[8:11], s55 offen lds
    s_waitcnt lgkmcnt(6)
    v_mfma_f32_16x16x32_bf16 v[168:171], v[208:211], v[16:19], v[168:171]
    ds_read_b64_tr_b16 v[228:229], v248 offset:31744
    v_mfma_f32_16x16x32_bf16 v[188:191], v[208:211], v[20:23], v[188:191]
    ds_read_b64_tr_b16 v[230:231], v248 offset:33024
    v_mfma_f32_16x16x32_bf16 v[172:175], v[212:215], v[16:19], v[172:175]
    ds_read_b64_tr_b16 v[232:233], v249 offset:31744
    v_mfma_f32_16x16x32_bf16 v[192:195], v[212:215], v[20:23], v[192:195]
    ds_read_b64_tr_b16 v[234:235], v249 offset:33024
    s_waitcnt lgkmcnt(8)
    v_mfma_f32_16x16x32_bf16 v[176:179], v[216:219], v[16:19], v[176:179]
    ds_read_b64_tr_b16 v[236:237], v250 offset:31744
    v_mfma_f32_16x16x32_bf16 v[196:199], v[216:219], v[20:23], v[196:199]
    ds_read_b64_tr_b16 v[238:239], v250 offset:33024
    s_waitcnt lgkmcnt(8)
    v_cmp_ne_u32 vcc, 1, v7
    s_cbranch_vccnz L_rs_5
L_rb_6:
    s_waitcnt lgkmcnt(6)
    v_mfma_f32_16x16x32_bf16 v[160:163], v[220:223], v[24:27], v[160:163]
    ds_read_b64_tr_b16 v[200:201], v246 offset:36864
    v_mfma_f32_16x16x32_bf16 v[180:183], v[220:223], v[28:31], v[180:183]
    ds_read_b64_tr_b16 v[202:203], v246 offset:38144
    s_add_u32 s55, s3, 1474560
    s_cmp_ge_u32 s55, 2457600
    s_cselect_b32 s51, 2457600, 0
    s_sub_u32 s55, s55, s51
    s_add_u32 s50, s57, 114688
    s_cmp_eq_u32 s61, 3
    s_cselect_b32 s50, 152576, s50
    s_mov_b32 m0, s50
    s_add_u32 s50, s50, 4096
    v_mfma_f32_16x16x32_bf16 v[164:167], v[224:227], v[24:27], v[164:167]
    ds_read_b64_tr_b16 v[204:205], v247 offset:36864
    v_mfma_f32_16x16x32_bf16 v[184:187], v[224:227], v[28:31], v[184:187]
    ds_read_b64_tr_b16 v[206:207], v247 offset:38144
    buffer_load_dwordx4 v251, s[8:11], s55 offen offset:0 lds
    s_waitcnt lgkmcnt(6)
    v_mfma_f32_16x16x32_bf16 v[168:171], v[228:231], v[24:27], v[168:171]
    ds_read_b64_tr_b16 v[208:209], v248 offset:36864
    v_mfma_f32_16x16x32_bf16 v[188:191], v[228:231], v[28:31], v[188:191]
    ds_read_b64_tr_b16 v[210:211], v248 offset:38144
    buffer_load_dwordx4 v252, s[8:11], s55 offen offset:1024 lds
    v_mfma_f32_16x16x32_bf16 v[172:175], v[232:235], v[24:27], v[172:175]
    ds_read_b64_tr_b16 v[212:213], v249 offset:36864
    v_mfma_f32_16x16x32_bf16 v[192:195], v[232:235], v[28:31], v[192:195]
    ds_read_b64_tr_b16 v[214:215], v249 offset:38144
    s_waitcnt lgkmcnt(8)
    v_mfma_f32_16x16x32_bf16 v[176:179], v[236:239], v[24:27], v[176:179]
    ds_read_b64_tr_b16 v[216:217], v250 offset:36864
    v_mfma_f32_16x16x32_bf16 v[196:199], v[236:239], v[28:31], v[196:199]
    ds_read_b64_tr_b16 v[218:219], v250 offset:38144
    s_waitcnt lgkmcnt(6)
    v_mfma_f32_16x16x32_bf16 v[160:163], v[200:203], v[32:35], v[160:163]
    ds_read_b64_tr_b16 v[220:221], v246 offset:41984
    v_mfma_f32_16x16x32_bf16 v[180:183], v[200:203], v[36:39], v[180:183]
    ds_read_b64_tr_b16 v[222:223], v246 offset:43264
    buffer_load_dwordx4 v253, s[8:11], s55 offen offset:2048 lds
    v_mfma_f32_16x16x32_bf16 v[164:167], v[204:207], v[32:35], v[164:167]
    ds_read_b64_tr_b16 v[224:225], v247 offset:41984
    v_mfma_f32_16x16x32_bf16 v[184:187], v[204:207], v[36:39], v[184:187]
    ds_read_b64_tr_b16 v[226:227], v247 offset:43264
    buffer_load_dwordx4 v254, s[8:11], s55 offen offset:3072 lds
    s_waitcnt lgkmcnt(6)
    v_mfma_f32_16x16x32_bf16 v[168:171], v[208:211], v[32:35], v[168:171]
    ds_read_b64_tr_b16 v[228:229], v248 offset:41984
    v_mfma_f32_16x16x32_bf16 v[188:191], v[208:211], v[36:39], v[188:191]
    ds_read_b64_tr_b16 v[230:231], v248 offset:43264
    v_mfma_f32_16x16x32_bf16 v[172:175], v[212:215], v[32:35], v[172:175]
    ds_read_b64_tr_b16 v[232:233], v249 offset:41984
    v_mfma_f32_16x16x32_bf16 v[192:195], v[212:215], v[36:39], v[192:195]
    ds_read_b64_tr_b16 v[234:235], v249 offset:43264
    s_waitcnt lgkmcnt(8)
    v_mfma_f32_16x16x32_bf16 v[176:179], v[216:219], v[32:35], v[176:179]
    ds_read_b64_tr_b16 v[236:237], v250 offset:41984
    v_mfma_f32_16x16x32_bf16 v[196:199], v[216:219], v[36:39], v[196:199]
    ds_read_b64_tr_b16 v[238:239], v250 offset:43264
    s_waitcnt lgkmcnt(6)
    v_mfma_f32_16x16x32_bf16 v[160:163], v[220:223], v[40:43], v[160:163]
    ds_read_b64_tr_b16 v[200:201], v246 offset:47104
    v_mfma_f32_16x16x32_bf16 v[180:183], v[220:223], v[44:47], v[180:183]
    ds_read_b64_tr_b16 v[202:203], v246 offset:48384
    s_waitcnt vmcnt(4)
    ds_write_b32 v4, v6 offset:16
    v_mfma_f32_16x16x32_bf16 v[164:167], v[224:227], v[40:43], v[164:167]
    ds_read_b64_tr_b16 v[204:205], v247 offset:47104
    v_mfma_f32_16x16x32_bf16 v[184:187], v[224:227], v[44:47], v[184:187]
    ds_read_b64_tr_b16 v[206:207], v247 offset:48384
    s_mov_b32 m0, s50
    s_nop 0
    buffer_load_dwordx4 v245, s[8:11], s55 offen lds
    s_waitcnt lgkmcnt(6)
    v_mfma_f32_16x16x32_bf16 v[168:171], v[228:231], v[40:43], v[168:171]
    ds_read_b64_tr_b16 v[208:209], v248 offset:47104
    v_mfma_f32_16x16x32_bf16 v[188:191], v[228:231], v[44:47], v[188:191]
    ds_read_b64_tr_b16 v[210:211], v248 offset:48384
    v_mfma_f32_16x16x32_bf16 v[172:175], v[232:235], v[40:43], v[172:175]
    ds_read_b64_tr_b16 v[212:213], v249 offset:47104
    v_mfma_f32_16x16x32_bf16 v[192:195], v[232:235], v[44:47], v[192:195]
    ds_read_b64_tr_b16 v[214:215], v249 offset:48384
    s_waitcnt lgkmcnt(8)
    v_mfma_f32_16x16x32_bf16 v[176:179], v[236:239], v[40:43], v[176:179]
    ds_read_b64_tr_b16 v[216:217], v250 offset:47104
    v_mfma_f32_16x16x32_bf16 v[196:199], v[236:239], v[44:47], v[196:199]
    ds_read_b64_tr_b16 v[218:219], v250 offset:48384
    v_add_u32 v246, 57344, v246
    v_add_u32 v247, 57344, v247
    v_add_u32 v248, 57344, v248
    v_add_u32 v249, 57344, v249
    v_add_u32 v250, 57344, v250
    s_waitcnt lgkmcnt(6)
    v_mfma_f32_16x16x32_bf16 v[160:163], v[200:203], v[48:51], v[160:163]
    ds_read_b64_tr_b16 v[220:221], v246 offset:32768
    v_mfma_f32_16x16x32_bf16 v[180:183], v[200:203], v[52:55], v[180:183]
    ds_read_b64_tr_b16 v[222:223], v246 offset:34048
    ds_read_b32 v7, v5 offset:16
    v_mfma_f32_16x16x32_bf16 v[164:167], v[204:207], v[48:51], v[164:167]
    ds_read_b64_tr_b16 v[224:225], v247 offset:32768
    v_mfma_f32_16x16x32_bf16 v[184:187], v[204:207], v[52:55], v[184:187]
    ds_read_b64_tr_b16 v[226:227], v247 offset:34048
    s_add_u32 s55, s3, 1966080
    s_cmp_ge_u32 s55, 2457600
    s_cselect_b32 s51, 2457600, 0
    s_sub_u32 s55, s55, s51
    s_add_u32 s50, s57, 4294950912
    s_mov_b32 m0, s50
    s_add_u32 s50, s50, 4096
    s_waitcnt lgkmcnt(6)
    v_mfma_f32_16x16x32_bf16 v[168:171], v[208:211], v[48:51], v[168:171]
    ds_read_b64_tr_b16 v[228:229], v248 offset:32768
    v_mfma_f32_16x16x32_bf16 v[188:191], v[208:211], v[52:55], v[188:191]
    ds_read_b64_tr_b16 v[230:231], v248 offset:34048
    buffer_load_dwordx4 v251, s[8:11], s55 offen offset:0 lds
    v_mfma_f32_16x16x32_bf16 v[172:175], v[212:215], v[48:51], v[172:175]
    ds_read_b64_tr_b16 v[232:233], v249 offset:32768
    v_mfma_f32_16x16x32_bf16 v[192:195], v[212:215], v[52:55], v[192:195]
    ds_read_b64_tr_b16 v[234:235], v249 offset:34048
    buffer_load_dwordx4 v252, s[8:11], s55 offen offset:1024 lds
    s_waitcnt lgkmcnt(8)
    v_mfma_f32_16x16x32_bf16 v[176:179], v[216:219], v[48:51], v[176:179]
    ds_read_b64_tr_b16 v[236:237], v250 offset:32768
    v_mfma_f32_16x16x32_bf16 v[196:199], v[216:219], v[52:55], v[196:199]
    ds_read_b64_tr_b16 v[238:239], v250 offset:34048
    s_waitcnt lgkmcnt(8)
    v_cmp_ne_u32 vcc, 1, v7
    s_cbranch_vccnz L_rs_7
L_rb_8:
    v_subrev_u32 v246, 57344, v246
    v_subrev_u32 v247, 57344, v247
    v_subrev_u32 v248, 57344, v248
    v_subrev_u32 v249, 57344, v249
    v_subrev_u32 v250, 57344, v250
    s_waitcnt lgkmcnt(6)
    v_mfma_f32_16x16x32_bf16 v[160:163], v[220:223], v[56:59], v[160:163]
    ds_read_b64_tr_b16 v[200:201], v246 offset:53248
    v_mfma_f32_16x16x32_bf16 v[180:183], v[220:223], v[60:63], v[180:183]
    ds_read_b64_tr_b16 v[202:203], v246 offset:54528
    buffer_load_dwordx4 v253, s[8:11], s55 offen offset:2048 lds
    v_mfma_f32_16x16x32_bf16 v[164:167], v[224:227], v[56:59], v[164:167]
    ds_read_b64_tr_b16 v[204:205], v247 offset:53248
    v_mfma_f32_16x16x32_bf16 v[184:187], v[224:227], v[60:63], v[184:187]
    ds_read_b64_tr_b16 v[206:207], v247 offset:54528
    buffer_load_dwordx4 v254, s[8:11], s55 offen offset:3072 lds
    s_waitcnt lgkmcnt(6)
    v_mfma_f32_16x16x32_bf16 v[168:171], v[228:231], v[56:59], v[168:171]
    ds_read_b64_tr_b16 v[208:209], v248 offset:53248
    v_mfma_f32_16x16x32_bf16 v[188:191], v[228:231], v[60:63], v[188:191]
    ds_read_b64_tr_b16 v[210:211], v248 offset:54528
    v_mfma_f32_16x16x32_bf16 v[172:175], v[232:235], v[56:59], v[172:175]
    ds_read_b64_tr_b16 v[212:213], v249 offset:53248
    v_mfma_f32_16x16x32_bf16 v[192:195], v[232:235], v[60:63], v[192:195]
    ds_read_b64_tr_b16 v[214:215], v249 offset:54528
    s_waitcnt lgkmcnt(8)
    v_mfma_f32_16x16x32_bf16 v[176:179], v[236:239], v[56:59], v[176:179]
    ds_read_b64_tr_b16 v[216:217], v250 offset:53248
    v_mfma_f32_16x16x32_bf16 v[196:199], v[236:239], v[60:63], v[196:199]
    ds_read_b64_tr_b16 v[218:219], v250 offset:54528
    s_waitcnt lgkmcnt(6)
    v_mfma_f32_16x16x32_bf16 v[160:163], v[200:203], v[64:67], v[160:163]
    ds_read_b64_tr_b16 v[220:221], v246 offset:58368
    v_mfma_f32_16x16x32_bf16 v[180:183], v[200:203], v[68:71], v[180:183]
    ds_read_b64_tr_b16 v[222:223], v246 offset:59648
    s_mov_b32 m0, s50
    s_nop 0
    buffer_load_dwordx4 v245, s[8:11], s55 offen lds
    v_mfma_f32_16x16x32_bf16 v[164:167], v[204:207], v[64:67], v[164:167]
    ds_read_b64_tr_b16 v[224:225], v247 offset:58368
    v_mfma_f32_16x16x32_bf16 v[184:187], v[204:207], v[68:71], v[184:187]
    ds_read_b64_tr_b16 v[226:227], v247 offset:59648
    s_waitcnt lgkmcnt(6)
    v_mfma_f32_16x16x32_bf16 v[168:171], v[208:211], v[64:67], v[168:171]
    ds_read_b64_tr_b16 v[228:229], v248 offset:58368
    v_mfma_f32_16x16x32_bf16 v[188:191], v[208:211], v[68:71], v[188:191]
    ds_read_b64_tr_b16 v[230:231], v248 offset:59648
    v_mfma_f32_16x16x32_bf16 v[172:175], v[212:215], v[64:67], v[172:175]
    ds_read_b64_tr_b16 v[232:233], v249 offset:58368
    v_mfma_f32_16x16x32_bf16 v[192:195], v[212:215], v[68:71], v[192:195]
    ds_read_b64_tr_b16 v[234:235], v249 offset:59648
    s_waitcnt lgkmcnt(8)
    v_mfma_f32_16x16x32_bf16 v[176:179], v[216:219], v[64:67], v[176:179]
    ds_read_b64_tr_b16 v[236:237], v250 offset:58368
    v_mfma_f32_16x16x32_bf16 v[196:199], v[216:219], v[68:71], v[196:199]
    ds_read_b64_tr_b16 v[238:239], v250 offset:59648
    s_waitcnt lgkmcnt(6)
    v_mfma_f32_16x16x32_bf16 v[160:163], v[220:223], v[72:75], v[160:163]
    ds_read_b64_tr_b16 v[200:201], v246 offset:63488
    v_mfma_f32_16x16x32_bf16 v[180:183], v[220:223], v[76:79], v[180:183]
    ds_read_b64_tr_b16 v[202:203], v246 offset:64768
    s_waitcnt vmcnt(5)
    ds_write_b32 v4, v6 offset:32
    v_mfma_f32_16x16x32_bf16 v[164:167], v[224:227], v[72:75], v[164:167]
    ds_read_b64_tr_b16 v[204:205], v247 offset:63488
    v_mfma_f32_16x16x32_bf16 v[184:187], v[224:227], v[76:79], v[184:187]
    ds_read_b64_tr_b16 v[206:207], v247 offset:64768
    s_waitcnt lgkmcnt(6)
    v_mfma_f32_16x16x32_bf16 v[168:171], v[228:231], v[72:75], v[168:171]
    ds_read_b64_tr_b16 v[208:209], v248 offset:63488
    v_mfma_f32_16x16x32_bf16 v[188:191], v[228:231], v[76:79], v[188:191]
    ds_read_b64_tr_b16 v[210:211], v248 offset:64768
    v_mfma_f32_16x16x32_bf16 v[172:175], v[232:235], v[72:75], v[172:175]
    ds_read_b64_tr_b16 v[212:213], v249 offset:63488
    v_mfma_f32_16x16x32_bf16 v[192:195], v[232:235], v[76:79], v[192:195]
    ds_read_b64_tr_b16 v[214:215], v249 offset:64768
    s_waitcnt lgkmcnt(8)
    v_mfma_f32_16x16x32_bf16 v[176:179], v[236:239], v[72:75], v[176:179]
    ds_read_b64_tr_b16 v[216:217], v250 offset:63488
    v_mfma_f32_16x16x32_bf16 v[196:199], v[236:239], v[76:79], v[196:199]
    ds_read_b64_tr_b16 v[218:219], v250 offset:64768
    v_add_u32 v246, 57344, v246
    v_add_u32 v247, 57344, v247
    v_add_u32 v248, 57344, v248
    v_add_u32 v249, 57344, v249
    v_add_u32 v250, 57344, v250
    s_waitcnt lgkmcnt(6)
    v_mfma_f32_16x16x32_bf16 v[160:163], v[200:203], v[80:83], v[160:163]
    ds_read_b64_tr_b16 v[220:221], v246 offset:11264
    v_mfma_f32_16x16x32_bf16 v[180:183], v[200:203], v[84:87], v[180:183]
    ds_read_b64_tr_b16 v[222:223], v246 offset:12544
    ds_read_b32 v7, v5 offset:32
    v_mfma_f32_16x16x32_bf16 v[164:167], v[204:207], v[80:83], v[164:167]
    ds_read_b64_tr_b16 v[224:225], v247 offset:11264
    v_mfma_f32_16x16x32_bf16 v[184:187], v[204:207], v[84:87], v[184:187]
    ds_read_b64_tr_b16 v[226:227], v247 offset:12544
    s_waitcnt lgkmcnt(6)
    v_mfma_f32_16x16x32_bf16 v[168:171], v[208:211], v[80:83], v[168:171]
    ds_read_b64_tr_b16 v[228:229], v248 offset:11264
    v_mfma_f32_16x16x32_bf16 v[188:191], v[208:211], v[84:87], v[188:191]
    ds_read_b64_tr_b16 v[230:231], v248 offset:12544
    v_mfma_f32_16x16x32_bf16 v[172:175], v[212:215], v[80:83], v[172:175]
    ds_read_b64_tr_b16 v[232:233], v249 offset:11264
    v_mfma_f32_16x16x32_bf16 v[192:195], v[212:215], v[84:87], v[192:195]
    ds_read_b64_tr_b16 v[234:235], v249 offset:12544
    s_waitcnt lgkmcnt(8)
    v_mfma_f32_16x16x32_bf16 v[176:179], v[216:219], v[80:83], v[176:179]
    ds_read_b64_tr_b16 v[236:237], v250 offset:11264
    v_mfma_f32_16x16x32_bf16 v[196:199], v[216:219], v[84:87], v[196:199]
    ds_read_b64_tr_b16 v[238:239], v250 offset:12544
    s_waitcnt lgkmcnt(8)
    v_cmp_ne_u32 vcc, 1, v7
    s_cbranch_vccnz L_rs_9
L_rb_10:
    s_waitcnt lgkmcnt(6)
    v_mfma_f32_16x16x32_bf16 v[160:163], v[220:223], v[88:91], v[160:163]
    ds_read_b64_tr_b16 v[200:201], v246 offset:16384
    v_mfma_f32_16x16x32_bf16 v[180:183], v[220:223], v[92:95], v[180:183]
    ds_read_b64_tr_b16 v[202:203], v246 offset:17664
    v_mfma_f32_16x16x32_bf16 v[164:167], v[224:227], v[88:91], v[164:167]
    ds_read_b64_tr_b16 v[204:205], v247 offset:16384
    v_mfma_f32_16x16x32_bf16 v[184:187], v[224:227], v[92:95], v[184:187]
    ds_read_b64_tr_b16 v[206:207], v247 offset:17664
    s_waitcnt lgkmcnt(6)
    v_mfma_f32_16x16x32_bf16 v[168:171], v[228:231], v[88:91], v[168:171]
    ds_read_b64_tr_b16 v[208:209], v248 offset:16384
    v_mfma_f32_16x16x32_bf16 v[188:191], v[228:231], v[92:95], v[188:191]
    ds_read_b64_tr_b16 v[210:211], v248 offset:17664
    v_mfma_f32_16x16x32_bf16 v[172:175], v[232:235], v[88:91], v[172:175]
    ds_read_b64_tr_b16 v[212:213], v249 offset:16384
    v_mfma_f32_16x16x32_bf16 v[192:195], v[232:235], v[92:95], v[192:195]
    ds_read_b64_tr_b16 v[214:215], v249 offset:17664
    s_waitcnt lgkmcnt(8)
    v_mfma_f32_16x16x32_bf16 v[176:179], v[236:239], v[88:91], v[176:179]
    ds_read_b64_tr_b16 v[216:217], v250 offset:16384
    v_mfma_f32_16x16x32_bf16 v[196:199], v[236:239], v[92:95], v[196:199]
    ds_read_b64_tr_b16 v[218:219], v250 offset:17664
    s_waitcnt lgkmcnt(6)
    v_mfma_f32_16x16x32_bf16 v[160:163], v[200:203], v[96:99], v[160:163]
    ds_read_b64_tr_b16 v[220:221], v246 offset:21504
    v_mfma_f32_16x16x32_bf16 v[180:183], v[200:203], v[100:103], v[180:183]
    ds_read_b64_tr_b16 v[222:223], v246 offset:22784
    v_mfma_f32_16x16x32_bf16 v[164:167], v[204:207], v[96:99], v[164:167]
    ds_read_b64_tr_b16 v[224:225], v247 offset:21504
    v_mfma_f32_16x16x32_bf16 v[184:187], v[204:207], v[100:103], v[184:187]
    ds_read_b64_tr_b16 v[226:227], v247 offset:22784
    s_waitcnt lgkmcnt(6)
    v_mfma_f32_16x16x32_bf16 v[168:171], v[208:211], v[96:99], v[168:171]
    ds_read_b64_tr_b16 v[228:229], v248 offset:21504
    v_mfma_f32_16x16x32_bf16 v[188:191], v[208:211], v[100:103], v[188:191]
    ds_read_b64_tr_b16 v[230:231], v248 offset:22784
    v_mfma_f32_16x16x32_bf16 v[172:175], v[212:215], v[96:99], v[172:175]
    ds_read_b64_tr_b16 v[232:233], v249 offset:21504
    v_mfma_f32_16x16x32_bf16 v[192:195], v[212:215], v[100:103], v[192:195]
    ds_read_b64_tr_b16 v[234:235], v249 offset:22784
    s_waitcnt lgkmcnt(8)
    v_mfma_f32_16x16x32_bf16 v[176:179], v[216:219], v[96:99], v[176:179]
    ds_read_b64_tr_b16 v[236:237], v250 offset:21504
    v_mfma_f32_16x16x32_bf16 v[196:199], v[216:219], v[100:103], v[196:199]
    ds_read_b64_tr_b16 v[238:239], v250 offset:22784
    s_waitcnt lgkmcnt(6)
    v_mfma_f32_16x16x32_bf16 v[160:163], v[220:223], v[104:107], v[160:163]
    ds_read_b64_tr_b16 v[200:201], v246 offset:26624
    v_mfma_f32_16x16x32_bf16 v[180:183], v[220:223], v[108:111], v[180:183]
    ds_read_b64_tr_b16 v[202:203], v246 offset:27904
    s_waitcnt vmcnt(0)
    ds_write_b32 v4, v6 offset:48
    v_mfma_f32_16x16x32_bf16 v[164:167], v[224:227], v[104:107], v[164:167]
    ds_read_b64_tr_b16 v[204:205], v247 offset:26624
    v_mfma_f32_16x16x32_bf16 v[184:187], v[224:227], v[108:111], v[184:187]
    ds_read_b64_tr_b16 v[206:207], v247 offset:27904
    s_waitcnt lgkmcnt(6)
    v_mfma_f32_16x16x32_bf16 v[168:171], v[228:231], v[104:107], v[168:171]
    ds_read_b64_tr_b16 v[208:209], v248 offset:26624
    v_mfma_f32_16x16x32_bf16 v[188:191], v[228:231], v[108:111], v[188:191]
    ds_read_b64_tr_b16 v[210:211], v248 offset:27904
    v_mfma_f32_16x16x32_bf16 v[172:175], v[232:235], v[104:107], v[172:175]
    ds_read_b64_tr_b16 v[212:213], v249 offset:26624
    v_mfma_f32_16x16x32_bf16 v[192:195], v[232:235], v[108:111], v[192:195]
    ds_read_b64_tr_b16 v[214:215], v249 offset:27904
    s_waitcnt lgkmcnt(8)
    v_mfma_f32_16x16x32_bf16 v[176:179], v[236:239], v[104:107], v[176:179]
    ds_read_b64_tr_b16 v[216:217], v250 offset:26624
    v_mfma_f32_16x16x32_bf16 v[196:199], v[236:239], v[108:111], v[196:199]
    ds_read_b64_tr_b16 v[218:219], v250 offset:27904
    s_waitcnt lgkmcnt(6)
    v_mfma_f32_16x16x32_bf16 v[160:163], v[200:203], v[112:115], v[160:163]
    ds_read_b64_tr_b16 v[220:221], v246 offset:37888
    v_mfma_f32_16x16x32_bf16 v[180:183], v[200:203], v[116:119], v[180:183]
    ds_read_b64_tr_b16 v[222:223], v246 offset:39168
    ds_read_b32 v7, v5 offset:48
    v_mfma_f32_16x16x32_bf16 v[164:167], v[204:207], v[112:115], v[164:167]
    ds_read_b64_tr_b16 v[224:225], v247 offset:37888
    v_mfma_f32_16x16x32_bf16 v[184:187], v[204:207], v[116:119], v[184:187]
    ds_read_b64_tr_b16 v[226:227], v247 offset:39168
    s_waitcnt lgkmcnt(6)
    v_mfma_f32_16x16x32_bf16 v[168:171], v[208:211], v[112:115], v[168:171]
    ds_read_b64_tr_b16 v[228:229], v248 offset:37888
    v_mfma_f32_16x16x32_bf16 v[188:191], v[208:211], v[116:119], v[188:191]
    ds_read_b64_tr_b16 v[230:231], v248 offset:39168
    v_mfma_f32_16x16x32_bf16 v[172:175], v[212:215], v[112:115], v[172:175]
    ds_read_b64_tr_b16 v[232:233], v249 offset:37888
    v_mfma_f32_16x16x32_bf16 v[192:195], v[212:215], v[116:119], v[192:195]
    ds_read_b64_tr_b16 v[234:235], v249 offset:39168
    s_waitcnt lgkmcnt(8)
    v_mfma_f32_16x16x32_bf16 v[176:179], v[216:219], v[112:115], v[176:179]
    ds_read_b64_tr_b16 v[236:237], v250 offset:37888
    v_mfma_f32_16x16x32_bf16 v[196:199], v[216:219], v[116:119], v[196:199]
    ds_read_b64_tr_b16 v[238:239], v250 offset:39168
    s_waitcnt lgkmcnt(8)
    v_cmp_ne_u32 vcc, 1, v7
    s_cbranch_vccnz L_rs_11
L_rb_12:
    v_subrev_u32 v246, 114688, v246
    v_subrev_u32 v247, 114688, v247
    v_subrev_u32 v248, 114688, v248
    v_subrev_u32 v249, 114688, v249
    v_subrev_u32 v250, 114688, v250
    s_waitcnt lgkmcnt(6)
    v_mfma_f32_16x16x32_bf16 v[160:163], v[220:223], v[120:123], v[160:163]
    ds_read_b64_tr_b16 v[200:201], v246 offset:0
    v_mfma_f32_16x16x32_bf16 v[180:183], v[220:223], v[124:127], v[180:183]
    ds_read_b64_tr_b16 v[202:203], v246 offset:1280
    v_mfma_f32_16x16x32_bf16 v[164:167], v[224:227], v[120:123], v[164:167]
    ds_read_b64_tr_b16 v[204:205], v247 offset:0
    v_mfma_f32_16x16x32_bf16 v[184:187], v[224:227], v[124:127], v[184:187]
    ds_read_b64_tr_b16 v[206:207], v247 offset:1280
    s_waitcnt lgkmcnt(6)
    v_mfma_f32_16x16x32_bf16 v[168:171], v[228:231], v[120:123], v[168:171]
    ds_read_b64_tr_b16 v[208:209], v248 offset:0
    v_mfma_f32_16x16x32_bf16 v[188:191], v[228:231], v[124:127], v[188:191]
    ds_read_b64_tr_b16 v[210:211], v248 offset:1280
    v_mfma_f32_16x16x32_bf16 v[172:175], v[232:235], v[120:123], v[172:175]
    ds_read_b64_tr_b16 v[212:213], v249 offset:0
    v_mfma_f32_16x16x32_bf16 v[192:195], v[232:235], v[124:127], v[192:195]
    ds_read_b64_tr_b16 v[214:215], v249 offset:1280
    s_waitcnt lgkmcnt(8)
    v_mfma_f32_16x16x32_bf16 v[176:179], v[236:239], v[120:123], v[176:179]
    ds_read_b64_tr_b16 v[216:217], v250 offset:0
    v_mfma_f32_16x16x32_bf16 v[196:199], v[236:239], v[124:127], v[196:199]
    ds_read_b64_tr_b16 v[218:219], v250 offset:1280
    s_waitcnt lgkmcnt(6)
    v_mfma_f32_16x16x32_bf16 v[160:163], v[200:203], v[128:131], v[160:163]
    ds_read_b64_tr_b16 v[220:221], v246 offset:5120
    v_mfma_f32_16x16x32_bf16 v[180:183], v[200:203], v[132:135], v[180:183]
    ds_read_b64_tr_b16 v[222:223], v246 offset:6400
    v_lshrrev_b32 v0, 4, v255
    v_mfma_f32_16x16x32_bf16 v[164:167], v[204:207], v[128:131], v[164:167]
    ds_read_b64_tr_b16 v[224:225], v247 offset:5120
    v_mfma_f32_16x16x32_bf16 v[184:187], v[204:207], v[132:135], v[184:187]
    ds_read_b64_tr_b16 v[226:227], v247 offset:6400
    v_mul_u32_u24 v0, 5120, v0
    s_waitcnt lgkmcnt(6)
    v_mfma_f32_16x16x32_bf16 v[168:171], v[208:211], v[128:131], v[168:171]
    ds_read_b64_tr_b16 v[228:229], v248 offset:5120
    v_mfma_f32_16x16x32_bf16 v[188:191], v[208:211], v[132:135], v[188:191]
    ds_read_b64_tr_b16 v[230:231], v248 offset:6400
    s_mul_i32 s51, s61, 1280
    v_mfma_f32_16x16x32_bf16 v[172:175], v[212:215], v[128:131], v[172:175]
    ds_read_b64_tr_b16 v[232:233], v249 offset:5120
    v_mfma_f32_16x16x32_bf16 v[192:195], v[212:215], v[132:135], v[192:195]
    ds_read_b64_tr_b16 v[234:235], v249 offset:6400
    s_add_u32 s51, s51, 36864
    s_waitcnt lgkmcnt(8)
    v_mfma_f32_16x16x32_bf16 v[176:179], v[216:219], v[128:131], v[176:179]
    ds_read_b64_tr_b16 v[236:237], v250 offset:5120
    v_mfma_f32_16x16x32_bf16 v[196:199], v[216:219], v[132:135], v[196:199]
    ds_read_b64_tr_b16 v[238:239], v250 offset:6400
    v_add_u32 v0, s51, v0
    s_waitcnt lgkmcnt(6)
    v_mfma_f32_16x16x32_bf16 v[160:163], v[220:223], v[136:139], v[160:163]
    ds_read_b64_tr_b16 v[200:201], v246 offset:10240
    v_mfma_f32_16x16x32_bf16 v[180:183], v[220:223], v[140:143], v[180:183]
    ds_read_b64_tr_b16 v[202:203], v246 offset:11520
    v_and_b32 v2, 15, v255
    v_mfma_f32_16x16x32_bf16 v[164:167], v[224:227], v[136:139], v[164:167]
    ds_read_b64_tr_b16 v[204:205], v247 offset:10240
    v_mfma_f32_16x16x32_bf16 v[184:187], v[224:227], v[140:143], v[184:187]
    ds_read_b64_tr_b16 v[206:207], v247 offset:11520
    v_lshl_add_u32 v1, v2, 3, v0
    s_waitcnt lgkmcnt(6)
    v_mfma_f32_16x16x32_bf16 v[168:171], v[228:231], v[136:139], v[168:171]
    ds_read_b64_tr_b16 v[208:209], v248 offset:10240
    v_mfma_f32_16x16x32_bf16 v[188:191], v[228:231], v[140:143], v[188:191]
    ds_read_b64_tr_b16 v[210:211], v248 offset:11520
    v_lshl_add_u32 v0, v2, 4, v0
    v_mfma_f32_16x16x32_bf16 v[172:175], v[232:235], v[136:139], v[172:175]
    ds_read_b64_tr_b16 v[212:213], v249 offset:10240
    v_mfma_f32_16x16x32_bf16 v[192:195], v[232:235], v[140:143], v[192:195]
    ds_read_b64_tr_b16 v[214:215], v249 offset:11520
    s_mov_b32 s50, 0x3ea52b5c
    s_mov_b32 s51, 0x3ea52b5c
    s_waitcnt lgkmcnt(8)
    v_mfma_f32_16x16x32_bf16 v[176:179], v[236:239], v[136:139], v[176:179]
    ds_read_b64_tr_b16 v[216:217], v250 offset:10240
    v_mfma_f32_16x16x32_bf16 v[196:199], v[236:239], v[140:143], v[196:199]
    ds_read_b64_tr_b16 v[218:219], v250 offset:11520
    s_waitcnt lgkmcnt(6)
    v_mfma_f32_16x16x32_bf16 v[160:163], v[200:203], v[144:147], v[160:163]
    ds_read_b64_tr_b16 v[220:221], v246 offset:15360
    v_mfma_f32_16x16x32_bf16 v[180:183], v[200:203], v[148:151], v[180:183]
    ds_read_b64_tr_b16 v[222:223], v246 offset:16640
    v_mfma_f32_16x16x32_bf16 v[164:167], v[204:207], v[144:147], v[164:167]
    ds_read_b64_tr_b16 v[224:225], v247 offset:15360
    v_mfma_f32_16x16x32_bf16 v[184:187], v[204:207], v[148:151], v[184:187]
    ds_read_b64_tr_b16 v[226:227], v247 offset:16640
    s_waitcnt lgkmcnt(6)
    v_mfma_f32_16x16x32_bf16 v[168:171], v[208:211], v[144:147], v[168:171]
    ds_read_b64_tr_b16 v[228:229], v248 offset:15360
    v_mfma_f32_16x16x32_bf16 v[188:191], v[208:211], v[148:151], v[188:191]
    ds_read_b64_tr_b16 v[230:231], v248 offset:16640
    v_mfma_f32_16x16x32_bf16 v[172:175], v[212:215], v[144:147], v[172:175]
    ds_read_b64_tr_b16 v[232:233], v249 offset:15360
    v_mfma_f32_16x16x32_bf16 v[192:195], v[212:215], v[148:151], v[192:195]
    ds_read_b64_tr_b16 v[234:235], v249 offset:16640
    s_waitcnt lgkmcnt(8)
    v_mfma_f32_16x16x32_bf16 v[176:179], v[216:219], v[144:147], v[176:179]
    ds_read_b64_tr_b16 v[236:237], v250 offset:15360
    v_mfma_f32_16x16x32_bf16 v[196:199], v[216:219], v[148:151], v[196:199]
    ds_read_b64_tr_b16 v[238:239], v250 offset:16640
    s_waitcnt lgkmcnt(6)
    v_mfma_f32_16x16x32_bf16 v[160:163], v[220:223], v[152:155], v[160:163]
    v_mfma_f32_16x16x32_bf16 v[180:183], v[220:223], v[156:159], v[180:183]
    v_mfma_f32_16x16x32_bf16 v[164:167], v[224:227], v[152:155], v[164:167]
    v_mfma_f32_16x16x32_bf16 v[184:187], v[224:227], v[156:159], v[184:187]
    s_waitcnt lgkmcnt(0)
    v_mfma_f32_16x16x32_bf16 v[168:171], v[228:231], v[152:155], v[168:171]
    v_mfma_f32_16x16x32_bf16 v[188:191], v[228:231], v[156:159], v[188:191]
    v_mfma_f32_16x16x32_bf16 v[172:175], v[232:235], v[152:155], v[172:175]
    v_mfma_f32_16x16x32_bf16 v[192:195], v[232:235], v[156:159], v[192:195]
    v_mfma_f32_16x16x32_bf16 v[176:179], v[236:239], v[152:155], v[176:179]
    v_mfma_f32_16x16x32_bf16 v[196:199], v[236:239], v[156:159], v[196:199]
    s_nop 4
    v_pk_mul_f32 v[160:161], v[160:161], s[50:51]
    v_pk_mul_f32 v[162:163], v[162:163], s[50:51]
    v_pk_mul_f32 v[164:165], v[164:165], s[50:51]
    v_pk_mul_f32 v[166:167], v[166:167], s[50:51]
    v_pk_mul_f32 v[168:169], v[168:169], s[50:51]
    v_pk_mul_f32 v[170:171], v[170:171], s[50:51]
    v_pk_mul_f32 v[172:173], v[172:173], s[50:51]
    v_pk_mul_f32 v[174:175], v[174:175], s[50:51]
    v_pk_mul_f32 v[176:177], v[176:177], s[50:51]
    v_pk_mul_f32 v[178:179], v[178:179], s[50:51]
    v_cvt_pk_bf16_f32 v160, v160, v161
    v_cvt_pk_bf16_f32 v161, v162, v163
    v_cvt_pk_bf16_f32 v162, v164, v165
    v_cvt_pk_bf16_f32 v163, v166, v167
    v_cvt_pk_bf16_f32 v164, v168, v169
    v_cvt_pk_bf16_f32 v165, v170, v171
    v_cvt_pk_bf16_f32 v166, v172, v173
    v_cvt_pk_bf16_f32 v167, v174, v175
    v_cvt_pk_bf16_f32 v168, v176, v177
    v_cvt_pk_bf16_f32 v169, v178, v179
    ds_write_b128 v0, v[160:163] offset:0
    ds_write_b128 v0, v[164:167] offset:512
    ds_write_b64 v1, v[168:169] offset:1024
    v_pk_mul_f32 v[180:181], v[180:181], s[50:51]
    v_pk_mul_f32 v[182:183], v[182:183], s[50:51]
    v_pk_mul_f32 v[184:185], v[184:185], s[50:51]
    v_pk_mul_f32 v[186:187], v[186:187], s[50:51]
    v_pk_mul_f32 v[188:189], v[188:189], s[50:51]
    v_pk_mul_f32 v[190:191], v[190:191], s[50:51]
    v_pk_mul_f32 v[192:193], v[192:193], s[50:51]
    v_pk_mul_f32 v[194:195], v[194:195], s[50:51]
    v_pk_mul_f32 v[196:197], v[196:197], s[50:51]
    v_pk_mul_f32 v[198:199], v[198:199], s[50:51]
    v_cvt_pk_bf16_f32 v180, v180, v181
    v_cvt_pk_bf16_f32 v181, v182, v183
    v_cvt_pk_bf16_f32 v182, v184, v185
    v_cvt_pk_bf16_f32 v183, v186, v187
    v_cvt_pk_bf16_f32 v184, v188, v189
    v_cvt_pk_bf16_f32 v185, v190, v191
    v_cvt_pk_bf16_f32 v186, v192, v193
    v_cvt_pk_bf16_f32 v187, v194, v195
    v_cvt_pk_bf16_f32 v188, v196, v197
    v_cvt_pk_bf16_f32 v189, v198, v199
    ds_write_b128 v0, v[180:183] offset:256
    ds_write_b128 v0, v[184:187] offset:768
    ds_write_b64 v1, v[188:189] offset:1152
    s_waitcnt lgkmcnt(0)
    v_mov_b32 v245, 163836
    s_barrier
    ds_read_b32 v245, v245
    s_setprio 0
    buffer_load_dwordx4 v[144:147], v240, s[12:15], s59 offen offset:0 sc1
    buffer_load_dwordx2 v[160:161], v241, s[12:15], s59 offen offset:2048 sc1
    v_and_b32 v64, 31, v255
    v_cmp_eq_u32 vcc, 20, v64
    v_mov_b32 v65, 0x3f803f80
    v_mov_b64 v[136:137], 0
    v_cndmask_b32 v64, 0, v65, vcc
    v_mov_b32 v65, v64
    v_mov_b64 v[164:165], v[64:65]
    v_mov_b64 v[166:167], v[64:65]
    v_mov_b64 v[168:169], v[64:65]
    v_mov_b64 v[170:171], v[64:65]
    s_mov_b64 exec, s[62:63]
    buffer_load_dwordx4 v[164:167], v242, s[12:15], s59 offen offset:0 sc1
    buffer_load_dwordx4 v[168:171], v242, s[12:15], s59 offen offset:640 sc1
    s_mov_b64 exec, -1
    buffer_load_dwordx4 v[148:151], v240, s[12:15], s59 offen offset:1024 sc1
    v_mov_b64 v[172:173], v[64:65]
    v_mov_b64 v[174:175], v[64:65]
    v_mov_b64 v[176:177], v[64:65]
    v_mov_b64 v[178:179], v[64:65]
    s_mov_b64 exec, s[62:63]
    buffer_load_dwordx4 v[172:175], v242, s[12:15], s59 offen offset:1280 sc1
    buffer_load_dwordx4 v[176:179], v242, s[12:15], s59 offen offset:1920 sc1
    s_mov_b64 exec, -1
    s_add_u32 s59, s59, 10240
    s_cmp_ge_u32 s59, 163840
    s_cselect_b32 s52, 163840, 0
    s_sub_u32 s59, s59, s52
    buffer_load_dwordx4 v[152:155], v240, s[12:15], s59 offen offset:0 sc1
    v_mov_b64 v[180:181], v[64:65]
    v_mov_b64 v[182:183], v[64:65]
    v_mov_b64 v[184:185], v[64:65]
    v_mov_b64 v[186:187], v[64:65]
    s_mov_b64 exec, s[62:63]
    buffer_load_dwordx4 v[180:183], v242, s[12:15], s59 offen offset:0 sc1
    buffer_load_dwordx4 v[184:187], v242, s[12:15], s59 offen offset:640 sc1
    s_mov_b64 exec, -1
    buffer_load_dwordx4 v[156:159], v240, s[12:15], s59 offen offset:1024 sc1
    buffer_load_dwordx2 v[162:163], v241, s[12:15], s59 offen offset:2048 sc1
    v_mov_b64 v[188:189], v[64:65]
    v_mov_b64 v[190:191], v[64:65]
    v_mov_b64 v[192:193], v[64:65]
    v_mov_b64 v[194:195], v[64:65]
    s_mul_i32 s51, s61, 5120
    s_add_u32 s51, s51, 36864
    v_add_u32 v247, s51, v240
    v_lshrrev_b32 v248, 5, v255
    v_lshl_add_u32 v248, v248, 10, v241
    v_add_u32 v248, s51, v248
    ds_read_b64 v[212:213], v248 offset:1024
    ds_read_b128 v[196:199], v247 offset:0
    ds_read_b128 v[200:203], v247 offset:1280
    ds_read_b64 v[214:215], v248 offset:3584
    ds_read_b128 v[204:207], v247 offset:2560
    ds_read_b128 v[208:211], v247 offset:3840
    v_mfma_f32_32x32x8_bf16 v[0:15], v[136:137], v[136:137], 0
    v_mfma_f32_32x32x8_bf16 v[16:31], v[136:137], v[136:137], 0
    v_mfma_f32_32x32x8_bf16 v[32:47], v[136:137], v[136:137], 0
    v_mfma_f32_32x32x8_bf16 v[48:63], v[136:137], v[136:137], 0
    v_mov_b64 v[138:139], 0
    v_mov_b64 v[140:141], 0
    v_mov_b64 v[142:143], 0
    s_mov_b64 s[8:9], s[20:21]
    s_mov_b32 s10, 819200
    s_mov_b32 s11, 0x00020000
    s_cmp_gt_u32 s47, 4
    s_cselect_b32 s52, 122880, 0
    s_lshl_b32 s57, s47, 10
    s_sub_u32 s57, s57, 15360
    s_add_u32 s57, s57, s52
    s_mul_i32 s55, s46, 160
    s_lshl3_add_u32 s55, s52, s55
    s_sub_u32 s55, s55, 122880
    s_mov_b64 s[40:41], s[32:33]
    s_mov_b32 s42, 0
    s_mov_b32 s43, 0x00020000
    s_waitcnt lgkmcnt(6)
    v_readfirstlane_b32 s34, v245
    s_nop 1
    s_and_b32 s34, s34, 1
    s_lshl_b32 s3, s34, 2
L_att_4:
    s_mov_b32 s53, 0
    s_waitcnt vmcnt(8) lgkmcnt(0)
    v_mfma_f32_32x32x4_2b_bf16 v[64:95], v[160:161], v[212:213], 0 cbsz:1 abid:0
    s_nop 15
    s_nop 1
    v_mfma_f32_32x32x16_bf16 v[64:79], v[144:147], v[196:199], v[64:79]
    v_mfma_f32_32x32x16_bf16 v[80:95], v[144:147], v[200:203], v[80:95]
    s_setprio 3
    s_nop 7
    s_nop 1
.p2align 6
L_al_13:
    s_bitcmp1_b32 s3, 3
    s_cbranch_scc1 L_hB_20
L_hBb_21:
    v_mfma_f32_32x32x16_bf16 v[48:63], v[188:191], v[136:139], v[48:63]
    v_exp_f32 v64, v64
    v_exp_f32 v65, v65
    v_exp_f32 v66, v66
    v_cvt_pk_bf16_f32 v128, v64, v65
    v_exp_f32 v67, v67
    v_mfma_f32_32x32x4_2b_bf16 v[96:127], v[160:161], v[214:215], 0 cbsz:1 abid:0
    v_cvt_pk_bf16_f32 v129, v66, v67
    v_exp_f32 v68, v68
    v_exp_f32 v69, v69
    v_exp_f32 v70, v70
    v_cvt_pk_bf16_f32 v130, v68, v69
    v_exp_f32 v71, v71
    v_exp_f32 v72, v72
    v_cvt_pk_bf16_f32 v131, v70, v71
    v_exp_f32 v73, v73
    v_exp_f32 v74, v74
    v_cvt_pk_bf16_f32 v132, v72, v73
    v_exp_f32 v75, v75
    v_mfma_f32_32x32x16_bf16 v[48:63], v[192:195], v[140:143], v[48:63]
    v_cvt_pk_bf16_f32 v133, v74, v75
    v_exp_f32 v76, v76
    v_exp_f32 v77, v77
    v_exp_f32 v78, v78
    v_exp_f32 v79, v79
    v_cvt_pk_bf16_f32 v134, v76, v77
    v_cvt_pk_bf16_f32 v135, v78, v79
    s_bitcmp1_b32 s3, 0
    s_cbranch_scc1 L_hA_14
L_hAb_15:
    v_mfma_f32_32x32x16_bf16 v[0:15], v[164:167], v[128:131], v[0:15]
    v_exp_f32 v80, v80
    v_exp_f32 v81, v81
    v_exp_f32 v82, v82
    v_cvt_pk_bf16_f32 v136, v80, v81
    s_mov_b64 exec, s[62:63]
    buffer_load_dwordx4 v[188:191], v242, s[12:15], s59 offen offset:1280 sc1
    buffer_load_dwordx4 v[192:195], v242, s[12:15], s59 offen offset:1920 sc1
    s_mov_b64 exec, -1
    v_exp_f32 v83, v83
    s_add_u32 s59, s59, 10240
    v_mfma_f32_32x32x16_bf16 v[96:111], v[144:147], v[204:207], v[96:111]
    v_cvt_pk_bf16_f32 v137, v82, v83
    v_exp_f32 v84, v84
    v_exp_f32 v85, v85
    v_exp_f32 v86, v86
    v_cvt_pk_bf16_f32 v138, v84, v85
    s_cmp_ge_u32 s59, 163840
    v_exp_f32 v87, v87
    s_cselect_b32 s52, 163840, 0
    v_mfma_f32_32x32x16_bf16 v[0:15], v[168:171], v[132:135], v[0:15]
    v_cvt_pk_bf16_f32 v139, v86, v87
    v_exp_f32 v88, v88
    v_exp_f32 v89, v89
    v_exp_f32 v90, v90
    v_cvt_pk_bf16_f32 v140, v88, v89
    s_sub_u32 s59, s59, s52
    v_exp_f32 v91, v91
    v_mfma_f32_32x32x16_bf16 v[112:127], v[144:147], v[208:211], v[112:127]
    v_cvt_pk_bf16_f32 v141, v90, v91
    v_exp_f32 v92, v92
    v_exp_f32 v93, v93
    v_exp_f32 v94, v94
    v_exp_f32 v95, v95
    v_cvt_pk_bf16_f32 v142, v92, v93
    v_cvt_pk_bf16_f32 v143, v94, v95
    s_bitcmp1_b32 s3, 4
    s_cbranch_scc1 L_hC_22
L_hCb_23:
    s_waitcnt vmcnt(7)
    v_mfma_f32_32x32x16_bf16 v[16:31], v[164:167], v[136:139], v[16:31]
    v_exp_f32 v96, v96
    v_exp_f32 v97, v97
    v_exp_f32 v98, v98
    v_cvt_pk_bf16_f32 v128, v96, v97
    buffer_load_dwordx4 v[144:147], v240, s[12:15], s59 offen offset:0 sc1
    v_exp_f32 v99, v99
    v_mfma_f32_32x32x4_2b_bf16 v[64:95], v[160:161], v[212:213], 0 cbsz:1 abid:1
    v_cvt_pk_bf16_f32 v129, v98, v99
    v_exp_f32 v100, v100
    v_exp_f32 v101, v101
    v_exp_f32 v102, v102
    v_cvt_pk_bf16_f32 v130, v100, v101
    v_exp_f32 v103, v103
    v_exp_f32 v104, v104
    v_cvt_pk_bf16_f32 v131, v102, v103
    v_exp_f32 v105, v105
    v_exp_f32 v106, v106
    v_cvt_pk_bf16_f32 v132, v104, v105
    v_exp_f32 v107, v107
    v_mfma_f32_32x32x16_bf16 v[16:31], v[168:171], v[140:143], v[16:31]
    v_cvt_pk_bf16_f32 v133, v106, v107
    v_exp_f32 v108, v108
    v_exp_f32 v109, v109
    v_exp_f32 v110, v110
    v_exp_f32 v111, v111
    v_cvt_pk_bf16_f32 v134, v108, v109
    v_cvt_pk_bf16_f32 v135, v110, v111
    v_mfma_f32_32x32x16_bf16 v[32:47], v[164:167], v[128:131], v[32:47]
    v_exp_f32 v112, v112
    v_exp_f32 v113, v113
    v_exp_f32 v114, v114
    v_cvt_pk_bf16_f32 v136, v112, v113
    v_exp_f32 v115, v115
    v_mfma_f32_32x32x16_bf16 v[64:79], v[148:151], v[196:199], v[64:79]
    v_cvt_pk_bf16_f32 v137, v114, v115
    v_exp_f32 v116, v116
    v_exp_f32 v117, v117
    v_exp_f32 v118, v118
    v_cvt_pk_bf16_f32 v138, v116, v117
    v_exp_f32 v119, v119
    v_mfma_f32_32x32x16_bf16 v[32:47], v[168:171], v[132:135], v[32:47]
    v_cvt_pk_bf16_f32 v139, v118, v119
    v_exp_f32 v120, v120
    v_exp_f32 v121, v121
    v_exp_f32 v122, v122
    v_cvt_pk_bf16_f32 v140, v120, v121
    v_exp_f32 v123, v123
    v_mfma_f32_32x32x16_bf16 v[80:95], v[148:151], v[200:203], v[80:95]
    v_cvt_pk_bf16_f32 v141, v122, v123
    v_exp_f32 v124, v124
    v_exp_f32 v125, v125
    v_exp_f32 v126, v126
    v_exp_f32 v127, v127
    v_cvt_pk_bf16_f32 v142, v124, v125
    v_cvt_pk_bf16_f32 v143, v126, v127
    v_mfma_f32_32x32x16_bf16 v[48:63], v[164:167], v[136:139], v[48:63]
    v_exp_f32 v64, v64
    v_exp_f32 v65, v65
    v_exp_f32 v66, v66
    v_cvt_pk_bf16_f32 v128, v64, v65
    s_min_u32 s52, s57, 0x20000
    v_exp_f32 v67, v67
    s_add_u32 m0, s52, 61440
    v_mfma_f32_32x32x4_2b_bf16 v[96:127], v[160:161], v[214:215], 0 cbsz:1 abid:1
    v_cvt_pk_bf16_f32 v129, v66, v67
    v_exp_f32 v68, v68
    v_exp_f32 v69, v69
    v_exp_f32 v70, v70
    v_cvt_pk_bf16_f32 v130, v68, v69
    v_exp_f32 v71, v71
    v_exp_f32 v72, v72
    v_cvt_pk_bf16_f32 v131, v70, v71
    v_exp_f32 v73, v73
    v_exp_f32 v74, v74
    v_cvt_pk_bf16_f32 v132, v72, v73
    s_add_u32 s57, s57, 5120
    v_exp_f32 v75, v75
    buffer_load_dwordx4 v243, s[8:11], s55 offen lds
    v_mfma_f32_32x32x16_bf16 v[48:63], v[168:171], v[140:143], v[48:63]
    v_cvt_pk_bf16_f32 v133, v74, v75
    v_exp_f32 v76, v76
    v_exp_f32 v77, v77
    v_exp_f32 v78, v78
    v_exp_f32 v79, v79
    s_add_u32 s55, s55, 40960
    v_cvt_pk_bf16_f32 v134, v76, v77
    v_cvt_pk_bf16_f32 v135, v78, v79
    s_bitcmp1_b32 s3, 5
    s_cbranch_scc1 L_hE_28
L_hEb_29:
    v_mfma_f32_32x32x16_bf16 v[0:15], v[172:175], v[128:131], v[0:15]
    v_exp_f32 v80, v80
    v_exp_f32 v81, v81
    v_exp_f32 v82, v82
    v_cvt_pk_bf16_f32 v136, v80, v81
    s_mov_b64 exec, s[62:63]
    buffer_load_dwordx4 v[164:167], v242, s[12:15], s59 offen offset:0 sc1
    buffer_load_dwordx4 v[168:171], v242, s[12:15], s59 offen offset:640 sc1
    s_mov_b64 exec, -1
    v_exp_f32 v83, v83
    v_mfma_f32_32x32x16_bf16 v[96:111], v[148:151], v[204:207], v[96:111]
    v_cvt_pk_bf16_f32 v137, v82, v83
    v_exp_f32 v84, v84
    v_exp_f32 v85, v85
    v_exp_f32 v86, v86
    v_cvt_pk_bf16_f32 v138, v84, v85
    v_exp_f32 v87, v87
    v_mfma_f32_32x32x16_bf16 v[0:15], v[176:179], v[132:135], v[0:15]
    v_cvt_pk_bf16_f32 v139, v86, v87
    v_exp_f32 v88, v88
    v_exp_f32 v89, v89
    v_exp_f32 v90, v90
    v_cvt_pk_bf16_f32 v140, v88, v89
    v_exp_f32 v91, v91
    v_mfma_f32_32x32x16_bf16 v[112:127], v[148:151], v[208:211], v[112:127]
    v_cvt_pk_bf16_f32 v141, v90, v91
    v_exp_f32 v92, v92
    v_exp_f32 v93, v93
    v_exp_f32 v94, v94
    v_exp_f32 v95, v95
    v_cvt_pk_bf16_f32 v142, v92, v93
    v_cvt_pk_bf16_f32 v143, v94, v95
    s_waitcnt vmcnt(6)
    v_mfma_f32_32x32x16_bf16 v[16:31], v[172:175], v[136:139], v[16:31]
    v_exp_f32 v96, v96
    v_exp_f32 v97, v97
    v_exp_f32 v98, v98
    v_cvt_pk_bf16_f32 v128, v96, v97
    buffer_load_dwordx4 v[148:151], v240, s[12:15], s59 offen offset:1024 sc1
    v_exp_f32 v99, v99
    buffer_load_dwordx2 v[160:161], v241, s[12:15], s59 offen offset:2048 sc1
    v_mfma_f32_32x32x4_2b_bf16 v[64:95], v[162:163], v[212:213], 0 cbsz:1 abid:0
    v_cvt_pk_bf16_f32 v129, v98, v99
    v_exp_f32 v100, v100
    v_exp_f32 v101, v101
    v_exp_f32 v102, v102
    v_cvt_pk_bf16_f32 v130, v100, v101
    v_exp_f32 v103, v103
    v_exp_f32 v104, v104
    v_cvt_pk_bf16_f32 v131, v102, v103
    v_exp_f32 v105, v105
    v_exp_f32 v106, v106
    v_cvt_pk_bf16_f32 v132, v104, v105
    v_exp_f32 v107, v107
    v_mfma_f32_32x32x16_bf16 v[16:31], v[176:179], v[140:143], v[16:31]
    v_cvt_pk_bf16_f32 v133, v106, v107
    v_exp_f32 v108, v108
    v_exp_f32 v109, v109
    v_exp_f32 v110, v110
    v_exp_f32 v111, v111
    v_cvt_pk_bf16_f32 v134, v108, v109
    v_cvt_pk_bf16_f32 v135, v110, v111
    v_mfma_f32_32x32x16_bf16 v[32:47], v[172:175], v[128:131], v[32:47]
    v_exp_f32 v112, v112
    v_exp_f32 v113, v113
    v_exp_f32 v114, v114
    v_cvt_pk_bf16_f32 v136, v112, v113
    v_exp_f32 v115, v115
    v_mfma_f32_32x32x16_bf16 v[64:79], v[152:155], v[196:199], v[64:79]
    v_cvt_pk_bf16_f32 v137, v114, v115
    v_exp_f32 v116, v116
    v_exp_f32 v117, v117
    v_exp_f32 v118, v118
    v_cvt_pk_bf16_f32 v138, v116, v117
    v_exp_f32 v119, v119
    v_mfma_f32_32x32x16_bf16 v[32:47], v[176:179], v[132:135], v[32:47]
    v_cvt_pk_bf16_f32 v139, v118, v119
    v_exp_f32 v120, v120
    v_exp_f32 v121, v121
    v_exp_f32 v122, v122
    v_cvt_pk_bf16_f32 v140, v120, v121
    v_exp_f32 v123, v123
    v_mfma_f32_32x32x16_bf16 v[80:95], v[152:155], v[200:203], v[80:95]
    v_cvt_pk_bf16_f32 v141, v122, v123
    v_exp_f32 v124, v124
    v_exp_f32 v125, v125
    v_exp_f32 v126, v126
    v_exp_f32 v127, v127
    v_cvt_pk_bf16_f32 v142, v124, v125
    v_cvt_pk_bf16_f32 v143, v126, v127
    v_mfma_f32_32x32x16_bf16 v[48:63], v[172:175], v[136:139], v[48:63]
    v_exp_f32 v64, v64
    v_exp_f32 v65, v65
    v_exp_f32 v66, v66
    v_cvt_pk_bf16_f32 v128, v64, v65
    s_min_u32 s52, s57, 0x20000
    v_exp_f32 v67, v67
    s_add_u32 m0, s52, 61440
    v_mfma_f32_32x32x4_2b_bf16 v[96:127], v[162:163], v[214:215], 0 cbsz:1 abid:0
    v_cvt_pk_bf16_f32 v129, v66, v67
    v_exp_f32 v68, v68
    v_exp_f32 v69, v69
    v_exp_f32 v70, v70
    v_cvt_pk_bf16_f32 v130, v68, v69
    v_exp_f32 v71, v71
    v_exp_f32 v72, v72
    v_cvt_pk_bf16_f32 v131, v70, v71
    v_exp_f32 v73, v73
    v_exp_f32 v74, v74
    v_cvt_pk_bf16_f32 v132, v72, v73
    s_add_u32 s57, s57, 5120
    v_exp_f32 v75, v75
    buffer_load_dwordx4 v243, s[8:11], s55 offen lds
    v_mfma_f32_32x32x16_bf16 v[48:63], v[176:179], v[140:143], v[48:63]
    v_cvt_pk_bf16_f32 v133, v74, v75
    v_exp_f32 v76, v76
    v_exp_f32 v77, v77
    v_exp_f32 v78, v78
    v_exp_f32 v79, v79
    s_add_u32 s55, s55, 40960
    v_cvt_pk_bf16_f32 v134, v76, v77
    v_cvt_pk_bf16_f32 v135, v78, v79
    s_bitcmp1_b32 s3, 5
    s_cbranch_scc1 L_hD_26
L_hDb_27:
    v_mfma_f32_32x32x16_bf16 v[0:15], v[180:183], v[128:131], v[0:15]
    v_exp_f32 v80, v80
    v_exp_f32 v81, v81
    v_exp_f32 v82, v82
    v_cvt_pk_bf16_f32 v136, v80, v81
    s_mov_b64 exec, s[62:63]
    buffer_load_dwordx4 v[172:175], v242, s[12:15], s59 offen offset:1280 sc1
    buffer_load_dwordx4 v[176:179], v242, s[12:15], s59 offen offset:1920 sc1
    s_mov_b64 exec, -1
    v_exp_f32 v83, v83
    s_add_u32 s59, s59, 10240
    v_mfma_f32_32x32x16_bf16 v[96:111], v[152:155], v[204:207], v[96:111]
    v_cvt_pk_bf16_f32 v137, v82, v83
    v_exp_f32 v84, v84
    v_exp_f32 v85, v85
    v_exp_f32 v86, v86
    v_cvt_pk_bf16_f32 v138, v84, v85
    s_cmp_ge_u32 s59, 163840
    v_exp_f32 v87, v87
    s_cselect_b32 s52, 163840, 0
    v_mfma_f32_32x32x16_bf16 v[0:15], v[184:187], v[132:135], v[0:15]
    v_cvt_pk_bf16_f32 v139, v86, v87
    v_exp_f32 v88, v88
    v_exp_f32 v89, v89
    v_exp_f32 v90, v90
    v_cvt_pk_bf16_f32 v140, v88, v89
    s_sub_u32 s59, s59, s52
    v_exp_f32 v91, v91
    v_mfma_f32_32x32x16_bf16 v[112:127], v[152:155], v[208:211], v[112:127]
    v_cvt_pk_bf16_f32 v141, v90, v91
    v_exp_f32 v92, v92
    v_exp_f32 v93, v93
    v_exp_f32 v94, v94
    v_exp_f32 v95, v95
    v_cvt_pk_bf16_f32 v142, v92, v93
    s_setprio 2
    v_cvt_pk_bf16_f32 v143, v94, v95
    s_bitcmp1_b32 s3, 0
    s_cbranch_scc1 L_hK_16
L_hKb_17:
    s_waitcnt vmcnt(9)
    v_mfma_f32_32x32x16_bf16 v[16:31], v[180:183], v[136:139], v[16:31]
    v_exp_f32 v96, v96
    v_exp_f32 v97, v97
    v_exp_f32 v98, v98
    v_cvt_pk_bf16_f32 v128, v96, v97
    buffer_load_dwordx4 v[152:155], v240, s[12:15], s59 offen offset:0 sc1
    v_exp_f32 v99, v99
    v_mfma_f32_32x32x4_2b_bf16 v[64:95], v[162:163], v[212:213], 0 cbsz:1 abid:1
    v_cvt_pk_bf16_f32 v129, v98, v99
    v_exp_f32 v100, v100
    v_exp_f32 v101, v101
    v_exp_f32 v102, v102
    v_cvt_pk_bf16_f32 v130, v100, v101
    v_exp_f32 v103, v103
    v_exp_f32 v104, v104
    v_cvt_pk_bf16_f32 v131, v102, v103
    v_exp_f32 v105, v105
    v_exp_f32 v106, v106
    v_cvt_pk_bf16_f32 v132, v104, v105
    v_exp_f32 v107, v107
    v_mfma_f32_32x32x16_bf16 v[16:31], v[184:187], v[140:143], v[16:31]
    v_cvt_pk_bf16_f32 v133, v106, v107
    v_exp_f32 v108, v108
    v_exp_f32 v109, v109
    v_exp_f32 v110, v110
    v_exp_f32 v111, v111
    v_cvt_pk_bf16_f32 v134, v108, v109
    v_cvt_pk_bf16_f32 v135, v110, v111
    v_mfma_f32_32x32x16_bf16 v[32:47], v[180:183], v[128:131], v[32:47]
    v_exp_f32 v112, v112
    v_exp_f32 v113, v113
    v_exp_f32 v114, v114
    v_cvt_pk_bf16_f32 v136, v112, v113
    v_exp_f32 v115, v115
    v_mfma_f32_32x32x16_bf16 v[64:79], v[156:159], v[196:199], v[64:79]
    v_cvt_pk_bf16_f32 v137, v114, v115
    v_exp_f32 v116, v116
    v_exp_f32 v117, v117
    v_exp_f32 v118, v118
    v_cvt_pk_bf16_f32 v138, v116, v117
    v_exp_f32 v119, v119
    v_mfma_f32_32x32x16_bf16 v[32:47], v[184:187], v[132:135], v[32:47]
    v_cvt_pk_bf16_f32 v139, v118, v119
    v_exp_f32 v120, v120
    v_exp_f32 v121, v121
    v_exp_f32 v122, v122
    v_cvt_pk_bf16_f32 v140, v120, v121
    v_exp_f32 v123, v123
    v_mfma_f32_32x32x16_bf16 v[80:95], v[156:159], v[200:203], v[80:95]
    v_cvt_pk_bf16_f32 v141, v122, v123
    v_exp_f32 v124, v124
    v_exp_f32 v125, v125
    v_exp_f32 v126, v126
    v_exp_f32 v127, v127
    v_cvt_pk_bf16_f32 v142, v124, v125
    v_cvt_pk_bf16_f32 v143, v126, v127
    s_bitcmp1_b32 s3, 0
    s_cbranch_scc1 L_hP_18
L_hPb_19:
    v_mfma_f32_32x32x16_bf16 v[48:63], v[180:183], v[136:139], v[48:63]
    v_exp_f32 v64, v64
    v_exp_f32 v65, v65
    v_exp_f32 v66, v66
    v_cvt_pk_bf16_f32 v128, v64, v65
    s_min_u32 s52, s57, 0x20000
    v_exp_f32 v67, v67
    s_add_u32 m0, s52, 61440
    v_mfma_f32_32x32x4_2b_bf16 v[96:127], v[162:163], v[214:215], 0 cbsz:1 abid:1
    v_cvt_pk_bf16_f32 v129, v66, v67
    v_exp_f32 v68, v68
    v_exp_f32 v69, v69
    v_exp_f32 v70, v70
    v_cvt_pk_bf16_f32 v130, v68, v69
    v_exp_f32 v71, v71
    v_exp_f32 v72, v72
    v_cvt_pk_bf16_f32 v131, v70, v71
    v_exp_f32 v73, v73
    v_exp_f32 v74, v74
    v_cvt_pk_bf16_f32 v132, v72, v73
    s_add_u32 s57, s57, 5120
    v_exp_f32 v75, v75
    buffer_load_dwordx4 v243, s[8:11], s55 offen lds
    v_mfma_f32_32x32x16_bf16 v[48:63], v[184:187], v[140:143], v[48:63]
    v_cvt_pk_bf16_f32 v133, v74, v75
    v_exp_f32 v76, v76
    v_exp_f32 v77, v77
    v_exp_f32 v78, v78
    v_exp_f32 v79, v79
    s_add_u32 s55, s55, 40960
    v_cvt_pk_bf16_f32 v134, v76, v77
    s_setprio 1
    v_cvt_pk_bf16_f32 v135, v78, v79
    v_mfma_f32_32x32x16_bf16 v[0:15], v[188:191], v[128:131], v[0:15]
    v_exp_f32 v80, v80
    v_exp_f32 v81, v81
    v_exp_f32 v82, v82
    v_cvt_pk_bf16_f32 v136, v80, v81
    s_mov_b64 exec, s[62:63]
    buffer_load_dwordx4 v[180:183], v242, s[12:15], s59 offen offset:0 sc1
    buffer_load_dwordx4 v[184:187], v242, s[12:15], s59 offen offset:640 sc1
    s_mov_b64 exec, -1
    v_exp_f32 v83, v83
    s_lshl_b32 s3, s3, 1
    v_mfma_f32_32x32x16_bf16 v[96:111], v[156:159], v[204:207], v[96:111]
    v_cvt_pk_bf16_f32 v137, v82, v83
    v_exp_f32 v84, v84
    v_exp_f32 v85, v85
    v_exp_f32 v86, v86
    v_cvt_pk_bf16_f32 v138, v84, v85
    v_exp_f32 v87, v87
    v_mfma_f32_32x32x16_bf16 v[0:15], v[192:195], v[132:135], v[0:15]
    v_cvt_pk_bf16_f32 v139, v86, v87
    v_exp_f32 v88, v88
    v_exp_f32 v89, v89
    v_exp_f32 v90, v90
    v_cvt_pk_bf16_f32 v140, v88, v89
    v_exp_f32 v91, v91
    v_mfma_f32_32x32x16_bf16 v[112:127], v[156:159], v[208:211], v[112:127]
    v_cvt_pk_bf16_f32 v141, v90, v91
    v_exp_f32 v92, v92
    v_exp_f32 v93, v93
    v_exp_f32 v94, v94
    v_exp_f32 v95, v95
    v_cvt_pk_bf16_f32 v142, v92, v93
    v_cvt_pk_bf16_f32 v143, v94, v95
    s_waitcnt vmcnt(7)
    v_mfma_f32_32x32x16_bf16 v[16:31], v[188:191], v[136:139], v[16:31]
    v_exp_f32 v96, v96
    v_exp_f32 v97, v97
    v_exp_f32 v98, v98
    v_cvt_pk_bf16_f32 v128, v96, v97
    buffer_load_dwordx4 v[156:159], v240, s[12:15], s59 offen offset:1024 sc1
    v_exp_f32 v99, v99
    buffer_load_dwordx2 v[162:163], v241, s[12:15], s59 offen offset:2048 sc1
    v_mfma_f32_32x32x4_2b_bf16 v[64:95], v[160:161], v[212:213], 0 cbsz:1 abid:0
    v_cvt_pk_bf16_f32 v129, v98, v99
    v_exp_f32 v100, v100
    v_exp_f32 v101, v101
    v_exp_f32 v102, v102
    v_cvt_pk_bf16_f32 v130, v100, v101
    v_exp_f32 v103, v103
    v_exp_f32 v104, v104
    v_cvt_pk_bf16_f32 v131, v102, v103
    v_exp_f32 v105, v105
    v_exp_f32 v106, v106
    v_cvt_pk_bf16_f32 v132, v104, v105
    v_exp_f32 v107, v107
    v_mfma_f32_32x32x16_bf16 v[16:31], v[192:195], v[140:143], v[16:31]
    v_cvt_pk_bf16_f32 v133, v106, v107
    v_exp_f32 v108, v108
    v_exp_f32 v109, v109
    v_exp_f32 v110, v110
    v_exp_f32 v111, v111
    v_cvt_pk_bf16_f32 v134, v108, v109
    s_setprio 0
    v_cvt_pk_bf16_f32 v135, v110, v111
    v_mfma_f32_32x32x16_bf16 v[32:47], v[188:191], v[128:131], v[32:47]
    v_exp_f32 v112, v112
    v_exp_f32 v113, v113
    v_exp_f32 v114, v114
    v_cvt_pk_bf16_f32 v136, v112, v113
    s_add_u32 s53, s53, 1
    v_exp_f32 v115, v115
    s_cmp_lt_u32 s53, 2
    v_mfma_f32_32x32x16_bf16 v[64:79], v[144:147], v[196:199], v[64:79]
    v_cvt_pk_bf16_f32 v137, v114, v115
    v_exp_f32 v116, v116
    v_exp_f32 v117, v117
    v_exp_f32 v118, v118
    v_cvt_pk_bf16_f32 v138, v116, v117
    v_exp_f32 v119, v119
    v_mfma_f32_32x32x16_bf16 v[32:47], v[192:195], v[132:135], v[32:47]
    v_cvt_pk_bf16_f32 v139, v118, v119
    v_exp_f32 v120, v120
    v_exp_f32 v121, v121
    v_exp_f32 v122, v122
    v_cvt_pk_bf16_f32 v140, v120, v121
    v_exp_f32 v123, v123
    v_mfma_f32_32x32x16_bf16 v[80:95], v[144:147], v[200:203], v[80:95]
    v_cvt_pk_bf16_f32 v141, v122, v123
    v_exp_f32 v124, v124
    v_exp_f32 v125, v125
    v_exp_f32 v126, v126
    v_exp_f32 v127, v127
    v_cvt_pk_bf16_f32 v142, v124, v125
    s_setprio 3
    v_cvt_pk_bf16_f32 v143, v126, v127
    s_cbranch_scc1 L_al_13
.p2align 3
L_al_32:
    v_mfma_f32_32x32x16_bf16 v[48:63], v[188:191], v[136:139], v[48:63]
    v_exp_f32 v64, v64
    v_exp_f32 v65, v65
    v_exp_f32 v66, v66
    v_cvt_pk_bf16_f32 v128, v64, v65
    v_exp_f32 v67, v67
    v_mfma_f32_32x32x4_2b_bf16 v[96:127], v[160:161], v[214:215], 0 cbsz:1 abid:0
    v_cvt_pk_bf16_f32 v129, v66, v67
    v_exp_f32 v68, v68
    v_exp_f32 v69, v69
    v_exp_f32 v70, v70
    v_cvt_pk_bf16_f32 v130, v68, v69
    v_exp_f32 v71, v71
    v_exp_f32 v72, v72
    v_cvt_pk_bf16_f32 v131, v70, v71
    v_exp_f32 v73, v73
    v_exp_f32 v74, v74
    v_cvt_pk_bf16_f32 v132, v72, v73
    v_exp_f32 v75, v75
    v_mfma_f32_32x32x16_bf16 v[48:63], v[192:195], v[140:143], v[48:63]
    v_cvt_pk_bf16_f32 v133, v74, v75
    v_exp_f32 v76, v76
    v_exp_f32 v77, v77
    v_exp_f32 v78, v78
    v_exp_f32 v79, v79
    v_cvt_pk_bf16_f32 v134, v76, v77
    v_cvt_pk_bf16_f32 v135, v78, v79
    v_mfma_f32_32x32x16_bf16 v[0:15], v[164:167], v[128:131], v[0:15]
    v_exp_f32 v80, v80
    v_exp_f32 v81, v81
    v_exp_f32 v82, v82
    v_cvt_pk_bf16_f32 v136, v80, v81
    s_mov_b64 exec, s[62:63]
    buffer_load_dwordx4 v[188:191], v242, s[12:15], s59 offen offset:1280 sc1
    buffer_load_dwordx4 v[192:195], v242, s[12:15], s59 offen offset:1920 sc1
    s_mov_b64 exec, -1
    v_exp_f32 v83, v83
    s_add_u32 s59, s59, 10240
    v_mfma_f32_32x32x16_bf16 v[96:111], v[144:147], v[204:207], v[96:111]
    v_cvt_pk_bf16_f32 v137, v82, v83
    v_exp_f32 v84, v84
    v_exp_f32 v85, v85
    v_exp_f32 v86, v86
    v_cvt_pk_bf16_f32 v138, v84, v85
    s_cmp_ge_u32 s59, 163840
    v_exp_f32 v87, v87
    s_cselect_b32 s52, 163840, 0
    v_mfma_f32_32x32x16_bf16 v[0:15], v[168:171], v[132:135], v[0:15]
    v_cvt_pk_bf16_f32 v139, v86, v87
    v_exp_f32 v88, v88
    v_exp_f32 v89, v89
    v_exp_f32 v90, v90
    v_cvt_pk_bf16_f32 v140, v88, v89
    s_sub_u32 s59, s59, s52
    v_exp_f32 v91, v91
    v_mfma_f32_32x32x16_bf16 v[112:127], v[144:147], v[208:211], v[112:127]
    v_cvt_pk_bf16_f32 v141, v90, v91
    v_exp_f32 v92, v92
    v_exp_f32 v93, v93
    v_exp_f32 v94, v94
    v_exp_f32 v95, v95
    v_cvt_pk_bf16_f32 v142, v92, v93
    v_cvt_pk_bf16_f32 v143, v94, v95
    s_waitcnt vmcnt(7)
    v_mfma_f32_32x32x16_bf16 v[16:31], v[164:167], v[136:139], v[16:31]
    v_exp_f32 v96, v96
    v_exp_f32 v97, v97
    v_exp_f32 v98, v98
    v_cvt_pk_bf16_f32 v128, v96, v97
    buffer_load_dwordx4 v[144:147], v240, s[12:15], s59 offen offset:0 sc1
    v_exp_f32 v99, v99
    v_mfma_f32_32x32x4_2b_bf16 v[64:95], v[160:161], v[212:213], 0 cbsz:1 abid:1
    v_cvt_pk_bf16_f32 v129, v98, v99
    v_exp_f32 v100, v100
    v_exp_f32 v101, v101
    v_exp_f32 v102, v102
    v_cvt_pk_bf16_f32 v130, v100, v101
    v_exp_f32 v103, v103
    v_exp_f32 v104, v104
    v_cvt_pk_bf16_f32 v131, v102, v103
    v_exp_f32 v105, v105
    v_exp_f32 v106, v106
    v_cvt_pk_bf16_f32 v132, v104, v105
    v_exp_f32 v107, v107
    v_mfma_f32_32x32x16_bf16 v[16:31], v[168:171], v[140:143], v[16:31]
    v_cvt_pk_bf16_f32 v133, v106, v107
    v_exp_f32 v108, v108
    v_exp_f32 v109, v109
    v_exp_f32 v110, v110
    v_exp_f32 v111, v111
    v_cvt_pk_bf16_f32 v134, v108, v109
    v_cvt_pk_bf16_f32 v135, v110, v111
    v_mfma_f32_32x32x16_bf16 v[32:47], v[164:167], v[128:131], v[32:47]
    v_exp_f32 v112, v112
    v_exp_f32 v113, v113
    v_exp_f32 v114, v114
    v_cvt_pk_bf16_f32 v136, v112, v113
    v_exp_f32 v115, v115
    v_mfma_f32_32x32x16_bf16 v[64:79], v[148:151], v[196:199], v[64:79]
    v_cvt_pk_bf16_f32 v137, v114, v115
    v_exp_f32 v116, v116
    v_exp_f32 v117, v117
    v_exp_f32 v118, v118
    v_cvt_pk_bf16_f32 v138, v116, v117
    v_exp_f32 v119, v119
    v_mfma_f32_32x32x16_bf16 v[32:47], v[168:171], v[132:135], v[32:47]
    v_cvt_pk_bf16_f32 v139, v118, v119
    v_exp_f32 v120, v120
    v_exp_f32 v121, v121
    v_exp_f32 v122, v122
    v_cvt_pk_bf16_f32 v140, v120, v121
    v_exp_f32 v123, v123
    v_mfma_f32_32x32x16_bf16 v[80:95], v[148:151], v[200:203], v[80:95]
    v_cvt_pk_bf16_f32 v141, v122, v123
    v_exp_f32 v124, v124
    v_exp_f32 v125, v125
    v_exp_f32 v126, v126
    v_exp_f32 v127, v127
    v_cvt_pk_bf16_f32 v142, v124, v125
    v_cvt_pk_bf16_f32 v143, v126, v127
    v_mfma_f32_32x32x16_bf16 v[48:63], v[164:167], v[136:139], v[48:63]
    v_exp_f32 v64, v64
    v_exp_f32 v65, v65
    v_exp_f32 v66, v66
    v_cvt_pk_bf16_f32 v128, v64, v65
    s_min_u32 s52, s57, 0x20000
    v_exp_f32 v67, v67
    s_add_u32 m0, s52, 61440
    v_mfma_f32_32x32x4_2b_bf16 v[96:127], v[160:161], v[214:215], 0 cbsz:1 abid:1
    v_cvt_pk_bf16_f32 v129, v66, v67
    v_exp_f32 v68, v68
    v_exp_f32 v69, v69
    v_exp_f32 v70, v70
    v_cvt_pk_bf16_f32 v130, v68, v69
    v_exp_f32 v71, v71
    v_exp_f32 v72, v72
    v_cvt_pk_bf16_f32 v131, v70, v71
    v_exp_f32 v73, v73
    v_exp_f32 v74, v74
    v_cvt_pk_bf16_f32 v132, v72, v73
    s_add_u32 s57, s57, 5120
    v_exp_f32 v75, v75
    buffer_load_dwordx4 v243, s[8:11], s55 offen lds
    v_mfma_f32_32x32x16_bf16 v[48:63], v[168:171], v[140:143], v[48:63]
    v_cvt_pk_bf16_f32 v133, v74, v75
    v_exp_f32 v76, v76
    v_exp_f32 v77, v77
    v_exp_f32 v78, v78
    v_exp_f32 v79, v79
    s_add_u32 s55, s55, 40960
    v_cvt_pk_bf16_f32 v134, v76, v77
    v_cvt_pk_bf16_f32 v135, v78, v79
    v_mfma_f32_32x32x16_bf16 v[0:15], v[172:175], v[128:131], v[0:15]
    v_exp_f32 v80, v80
    v_exp_f32 v81, v81
    v_exp_f32 v82, v82
    v_cvt_pk_bf16_f32 v136, v80, v81
    s_mov_b64 exec, s[62:63]
    buffer_load_dwordx4 v[164:167], v242, s[12:15], s59 offen offset:0 sc1
    buffer_load_dwordx4 v[168:171], v242, s[12:15], s59 offen offset:640 sc1
    s_mov_b64 exec, -1
    v_exp_f32 v83, v83
    v_mfma_f32_32x32x16_bf16 v[96:111], v[148:151], v[204:207], v[96:111]
    v_cvt_pk_bf16_f32 v137, v82, v83
    v_exp_f32 v84, v84
    v_exp_f32 v85, v85
    v_exp_f32 v86, v86
    v_cvt_pk_bf16_f32 v138, v84, v85
    v_exp_f32 v87, v87
    v_mfma_f32_32x32x16_bf16 v[0:15], v[176:179], v[132:135], v[0:15]
    v_cvt_pk_bf16_f32 v139, v86, v87
    v_exp_f32 v88, v88
    v_exp_f32 v89, v89
    v_exp_f32 v90, v90
    v_cvt_pk_bf16_f32 v140, v88, v89
    v_exp_f32 v91, v91
    v_mfma_f32_32x32x16_bf16 v[112:127], v[148:151], v[208:211], v[112:127]
    v_cvt_pk_bf16_f32 v141, v90, v91
    v_exp_f32 v92, v92
    v_exp_f32 v93, v93
    v_exp_f32 v94, v94
    v_exp_f32 v95, v95
    v_cvt_pk_bf16_f32 v142, v92, v93
    v_cvt_pk_bf16_f32 v143, v94, v95
    s_waitcnt vmcnt(6)
    v_mfma_f32_32x32x16_bf16 v[16:31], v[172:175], v[136:139], v[16:31]
    v_exp_f32 v96, v96
    v_exp_f32 v97, v97
    v_exp_f32 v98, v98
    v_cvt_pk_bf16_f32 v128, v96, v97
    buffer_load_dwordx4 v[148:151], v240, s[12:15], s59 offen offset:1024 sc1
    v_exp_f32 v99, v99
    buffer_load_dwordx2 v[160:161], v241, s[12:15], s59 offen offset:2048 sc1
    v_mfma_f32_32x32x4_2b_bf16 v[64:95], v[162:163], v[212:213], 0 cbsz:1 abid:0
    v_cvt_pk_bf16_f32 v129, v98, v99
    v_exp_f32 v100, v100
    v_exp_f32 v101, v101
    v_exp_f32 v102, v102
    v_cvt_pk_bf16_f32 v130, v100, v101
    v_exp_f32 v103, v103
    v_exp_f32 v104, v104
    v_cvt_pk_bf16_f32 v131, v102, v103
    v_exp_f32 v105, v105
    v_exp_f32 v106, v106
    v_cvt_pk_bf16_f32 v132, v104, v105
    v_exp_f32 v107, v107
    v_mfma_f32_32x32x16_bf16 v[16:31], v[176:179], v[140:143], v[16:31]
    v_cvt_pk_bf16_f32 v133, v106, v107
    v_exp_f32 v108, v108
    v_exp_f32 v109, v109
    v_exp_f32 v110, v110
    v_exp_f32 v111, v111
    v_cvt_pk_bf16_f32 v134, v108, v109
    v_cvt_pk_bf16_f32 v135, v110, v111
    v_mfma_f32_32x32x16_bf16 v[32:47], v[172:175], v[128:131], v[32:47]
    v_exp_f32 v112, v112
    v_exp_f32 v113, v113
    v_exp_f32 v114, v114
    v_cvt_pk_bf16_f32 v136, v112, v113
    v_exp_f32 v115, v115
    v_mfma_f32_32x32x16_bf16 v[64:79], v[152:155], v[196:199], v[64:79]
    v_cvt_pk_bf16_f32 v137, v114, v115
    v_exp_f32 v116, v116
    v_exp_f32 v117, v117
    v_exp_f32 v118, v118
    v_cvt_pk_bf16_f32 v138, v116, v117
    v_exp_f32 v119, v119
    v_mfma_f32_32x32x16_bf16 v[32:47], v[176:179], v[132:135], v[32:47]
    v_cvt_pk_bf16_f32 v139, v118, v119
    v_exp_f32 v120, v120
    v_exp_f32 v121, v121
    v_exp_f32 v122, v122
    v_cvt_pk_bf16_f32 v140, v120, v121
    v_exp_f32 v123, v123
    v_mfma_f32_32x32x16_bf16 v[80:95], v[152:155], v[200:203], v[80:95]
    v_cvt_pk_bf16_f32 v141, v122, v123
    v_exp_f32 v124, v124
    v_exp_f32 v125, v125
    v_exp_f32 v126, v126
    v_exp_f32 v127, v127
    v_cvt_pk_bf16_f32 v142, v124, v125
    v_cvt_pk_bf16_f32 v143, v126, v127
    v_mfma_f32_32x32x16_bf16 v[48:63], v[172:175], v[136:139], v[48:63]
    v_exp_f32 v64, v64
    v_exp_f32 v65, v65
    v_exp_f32 v66, v66
    v_cvt_pk_bf16_f32 v128, v64, v65
    s_min_u32 s52, s57, 0x20000
    v_exp_f32 v67, v67
    s_add_u32 m0, s52, 61440
    v_mfma_f32_32x32x4_2b_bf16 v[96:127], v[162:163], v[214:215], 0 cbsz:1 abid:0
    v_cvt_pk_bf16_f32 v129, v66, v67
    v_exp_f32 v68, v68
    v_exp_f32 v69, v69
    v_exp_f32 v70, v70
    v_cvt_pk_bf16_f32 v130, v68, v69
    v_exp_f32 v71, v71
    v_exp_f32 v72, v72
    v_cvt_pk_bf16_f32 v131, v70, v71
    v_exp_f32 v73, v73
    v_exp_f32 v74, v74
    v_cvt_pk_bf16_f32 v132, v72, v73
    s_add_u32 s57, s57, 5120
    v_exp_f32 v75, v75
    buffer_load_dwordx4 v243, s[8:11], s55 offen lds
    v_mfma_f32_32x32x16_bf16 v[48:63], v[176:179], v[140:143], v[48:63]
    v_cvt_pk_bf16_f32 v133, v74, v75
    v_exp_f32 v76, v76
    v_exp_f32 v77, v77
    v_exp_f32 v78, v78
    v_exp_f32 v79, v79
    s_add_u32 s55, s55, 40960
    v_cvt_pk_bf16_f32 v134, v76, v77
    v_cvt_pk_bf16_f32 v135, v78, v79
    v_mfma_f32_32x32x16_bf16 v[0:15], v[180:183], v[128:131], v[0:15]
    v_exp_f32 v80, v80
    v_exp_f32 v81, v81
    v_exp_f32 v82, v82
    v_cvt_pk_bf16_f32 v136, v80, v81
    s_mov_b64 exec, s[62:63]
    buffer_load_dwordx4 v[172:175], v242, s[12:15], s59 offen offset:1280 sc1
    buffer_load_dwordx4 v[176:179], v242, s[12:15], s59 offen offset:1920 sc1
    s_mov_b64 exec, -1
    v_exp_f32 v83, v83
    s_add_u32 s59, s59, 10240
    v_mfma_f32_32x32x16_bf16 v[96:111], v[152:155], v[204:207], v[96:111]
    v_cvt_pk_bf16_f32 v137, v82, v83
    v_exp_f32 v84, v84
    v_exp_f32 v85, v85
    v_exp_f32 v86, v86
    v_cvt_pk_bf16_f32 v138, v84, v85
    s_cmp_ge_u32 s59, 163840
    v_exp_f32 v87, v87
    s_cselect_b32 s52, 163840, 0
    v_mfma_f32_32x32x16_bf16 v[0:15], v[184:187], v[132:135], v[0:15]
    v_cvt_pk_bf16_f32 v139, v86, v87
    v_exp_f32 v88, v88
    v_exp_f32 v89, v89
    v_exp_f32 v90, v90
    v_cvt_pk_bf16_f32 v140, v88, v89
    s_sub_u32 s59, s59, s52
    v_exp_f32 v91, v91
    v_mfma_f32_32x32x16_bf16 v[112:127], v[152:155], v[208:211], v[112:127]
    v_cvt_pk_bf16_f32 v141, v90, v91
    v_exp_f32 v92, v92
    v_exp_f32 v93, v93
    v_exp_f32 v94, v94
    v_exp_f32 v95, v95
    v_cvt_pk_bf16_f32 v142, v92, v93
    s_setprio 2
    v_cvt_pk_bf16_f32 v143, v94, v95
    s_waitcnt vmcnt(9)
    v_mfma_f32_32x32x16_bf16 v[16:31], v[180:183], v[136:139], v[16:31]
    v_exp_f32 v96, v96
    v_exp_f32 v97, v97
    v_exp_f32 v98, v98
    v_cvt_pk_bf16_f32 v128, v96, v97
    buffer_load_dwordx4 v[152:155], v240, s[12:15], s59 offen offset:0 sc1
    v_exp_f32 v99, v99
    v_mfma_f32_32x32x4_2b_bf16 v[64:95], v[162:163], v[212:213], 0 cbsz:1 abid:1
    v_cvt_pk_bf16_f32 v129, v98, v99
    v_exp_f32 v100, v100
    v_exp_f32 v101, v101
    v_exp_f32 v102, v102
    v_cvt_pk_bf16_f32 v130, v100, v101
    v_exp_f32 v103, v103
    v_exp_f32 v104, v104
    v_cvt_pk_bf16_f32 v131, v102, v103
    v_exp_f32 v105, v105
    v_exp_f32 v106, v106
    v_cvt_pk_bf16_f32 v132, v104, v105
    v_exp_f32 v107, v107
    v_mfma_f32_32x32x16_bf16 v[16:31], v[184:187], v[140:143], v[16:31]
    v_cvt_pk_bf16_f32 v133, v106, v107
    v_exp_f32 v108, v108
    v_exp_f32 v109, v109
    v_exp_f32 v110, v110
    v_exp_f32 v111, v111
    v_cvt_pk_bf16_f32 v134, v108, v109
    v_cvt_pk_bf16_f32 v135, v110, v111
    v_mfma_f32_32x32x16_bf16 v[32:47], v[180:183], v[128:131], v[32:47]
    v_exp_f32 v112, v112
    v_exp_f32 v113, v113
    v_exp_f32 v114, v114
    v_cvt_pk_bf16_f32 v136, v112, v113
    v_exp_f32 v115, v115
    v_mfma_f32_32x32x16_bf16 v[64:79], v[156:159], v[196:199], v[64:79]
    v_cvt_pk_bf16_f32 v137, v114, v115
    v_exp_f32 v116, v116
    v_exp_f32 v117, v117
    v_exp_f32 v118, v118
    v_cvt_pk_bf16_f32 v138, v116, v117
    v_exp_f32 v119, v119
    v_mfma_f32_32x32x16_bf16 v[32:47], v[184:187], v[132:135], v[32:47]
    v_cvt_pk_bf16_f32 v139, v118, v119
    v_exp_f32 v120, v120
    v_exp_f32 v121, v121
    v_exp_f32 v122, v122
    v_cvt_pk_bf16_f32 v140, v120, v121
    v_exp_f32 v123, v123
    v_mfma_f32_32x32x16_bf16 v[80:95], v[156:159], v[200:203], v[80:95]
    v_cvt_pk_bf16_f32 v141, v122, v123
    v_exp_f32 v124, v124
    v_exp_f32 v125, v125
    v_exp_f32 v126, v126
    v_exp_f32 v127, v127
    v_cvt_pk_bf16_f32 v142, v124, v125
    v_cvt_pk_bf16_f32 v143, v126, v127
    v_mfma_f32_32x32x16_bf16 v[48:63], v[180:183], v[136:139], v[48:63]
    v_exp_f32 v64, v64
    v_exp_f32 v65, v65
    v_exp_f32 v66, v66
    v_cvt_pk_bf16_f32 v128, v64, v65
    s_min_u32 s52, s57, 0x20000
    v_exp_f32 v67, v67
    s_add_u32 m0, s52, 61440
    v_mfma_f32_32x32x4_2b_bf16 v[96:127], v[162:163], v[214:215], 0 cbsz:1 abid:1
    v_cvt_pk_bf16_f32 v129, v66, v67
    v_exp_f32 v68, v68
    v_exp_f32 v69, v69
    v_exp_f32 v70, v70
    v_cvt_pk_bf16_f32 v130, v68, v69
    v_exp_f32 v71, v71
    v_exp_f32 v72, v72
    v_cvt_pk_bf16_f32 v131, v70, v71
    v_exp_f32 v73, v73
    v_exp_f32 v74, v74
    v_cvt_pk_bf16_f32 v132, v72, v73
    s_add_u32 s57, s57, 5120
    v_exp_f32 v75, v75
    buffer_load_dwordx4 v243, s[8:11], s55 offen lds
    v_mfma_f32_32x32x16_bf16 v[48:63], v[184:187], v[140:143], v[48:63]
    v_cvt_pk_bf16_f32 v133, v74, v75
    v_exp_f32 v76, v76
    v_exp_f32 v77, v77
    v_exp_f32 v78, v78
    v_exp_f32 v79, v79
    s_add_u32 s55, s55, 40960
    v_cvt_pk_bf16_f32 v134, v76, v77
    s_setprio 1
    v_cvt_pk_bf16_f32 v135, v78, v79
    v_mfma_f32_32x32x16_bf16 v[0:15], v[188:191], v[128:131], v[0:15]
    v_exp_f32 v80, v80
    v_exp_f32 v81, v81
    v_exp_f32 v82, v82
    v_cvt_pk_bf16_f32 v136, v80, v81
    s_mov_b64 exec, s[62:63]
    buffer_load_dwordx4 v[180:183], v242, s[12:15], s59 offen offset:0 sc1
    buffer_load_dwordx4 v[184:187], v242, s[12:15], s59 offen offset:640 sc1
    s_mov_b64 exec, -1
    v_exp_f32 v83, v83
    v_mfma_f32_32x32x16_bf16 v[96:111], v[156:159], v[204:207], v[96:111]
    v_cvt_pk_bf16_f32 v137, v82, v83
    v_exp_f32 v84, v84
    v_exp_f32 v85, v85
    v_exp_f32 v86, v86
    v_cvt_pk_bf16_f32 v138, v84, v85
    v_exp_f32 v87, v87
    v_mfma_f32_32x32x16_bf16 v[0:15], v[192:195], v[132:135], v[0:15]
    v_cvt_pk_bf16_f32 v139, v86, v87
    v_exp_f32 v88, v88
    v_exp_f32 v89, v89
    v_exp_f32 v90, v90
    v_cvt_pk_bf16_f32 v140, v88, v89
    v_exp_f32 v91, v91
    v_mfma_f32_32x32x16_bf16 v[112:127], v[156:159], v[208:211], v[112:127]
    v_cvt_pk_bf16_f32 v141, v90, v91
    v_exp_f32 v92, v92
    v_exp_f32 v93, v93
    v_exp_f32 v94, v94
    v_exp_f32 v95, v95
    v_cvt_pk_bf16_f32 v142, v92, v93
    v_cvt_pk_bf16_f32 v143, v94, v95
    s_waitcnt vmcnt(7)
    v_mfma_f32_32x32x16_bf16 v[16:31], v[188:191], v[136:139], v[16:31]
    v_exp_f32 v96, v96
    v_exp_f32 v97, v97
    v_exp_f32 v98, v98
    v_cvt_pk_bf16_f32 v128, v96, v97
    buffer_load_dwordx4 v[156:159], v240, s[12:15], s59 offen offset:1024 sc1
    v_exp_f32 v99, v99
    buffer_load_dwordx2 v[162:163], v241, s[12:15], s59 offen offset:2048 sc1
    v_mfma_f32_32x32x4_2b_bf16 v[64:95], v[160:161], v[212:213], 0 cbsz:1 abid:0
    v_cvt_pk_bf16_f32 v129, v98, v99
    v_exp_f32 v100, v100
    v_exp_f32 v101, v101
    v_exp_f32 v102, v102
    v_cvt_pk_bf16_f32 v130, v100, v101
    v_exp_f32 v103, v103
    v_exp_f32 v104, v104
    v_cvt_pk_bf16_f32 v131, v102, v103
    v_exp_f32 v105, v105
    v_exp_f32 v106, v106
    v_cvt_pk_bf16_f32 v132, v104, v105
    v_exp_f32 v107, v107
    v_mfma_f32_32x32x16_bf16 v[16:31], v[192:195], v[140:143], v[16:31]
    v_cvt_pk_bf16_f32 v133, v106, v107
    v_exp_f32 v108, v108
    v_exp_f32 v109, v109
    v_exp_f32 v110, v110
    v_exp_f32 v111, v111
    v_cvt_pk_bf16_f32 v134, v108, v109
    s_setprio 0
    v_cvt_pk_bf16_f32 v135, v110, v111
    v_mfma_f32_32x32x16_bf16 v[32:47], v[188:191], v[128:131], v[32:47]
    v_exp_f32 v112, v112
    v_exp_f32 v113, v113
    v_exp_f32 v114, v114
    v_cvt_pk_bf16_f32 v136, v112, v113
    s_add_u32 s53, s53, 1
    v_exp_f32 v115, v115
    s_cmp_lt_u32 s53, 7
    v_mfma_f32_32x32x16_bf16 v[64:79], v[144:147], v[196:199], v[64:79]
    v_cvt_pk_bf16_f32 v137, v114, v115
    v_exp_f32 v116, v116
    v_exp_f32 v117, v117
    v_exp_f32 v118, v118
    v_cvt_pk_bf16_f32 v138, v116, v117
    v_exp_f32 v119, v119
    v_mfma_f32_32x32x16_bf16 v[32:47], v[192:195], v[132:135], v[32:47]
    v_cvt_pk_bf16_f32 v139, v118, v119
    v_exp_f32 v120, v120
    v_exp_f32 v121, v121
    v_exp_f32 v122, v122
    v_cvt_pk_bf16_f32 v140, v120, v121
    v_exp_f32 v123, v123
    v_mfma_f32_32x32x16_bf16 v[80:95], v[144:147], v[200:203], v[80:95]
    v_cvt_pk_bf16_f32 v141, v122, v123
    v_exp_f32 v124, v124
    v_exp_f32 v125, v125
    v_exp_f32 v126, v126
    v_exp_f32 v127, v127
    v_cvt_pk_bf16_f32 v142, v124, v125
    s_setprio 3
    v_cvt_pk_bf16_f32 v143, v126, v127
    s_cbranch_scc1 L_al_32
    v_mfma_f32_32x32x16_bf16 v[48:63], v[188:191], v[136:139], v[48:63]
    v_exp_f32 v64, v64
    v_exp_f32 v65, v65
    v_exp_f32 v66, v66
    v_cvt_pk_bf16_f32 v128, v64, v65
    s_min_u32 s52, s57, 0x20000
    v_exp_f32 v67, v67
    s_add_u32 m0, s52, 61440
    v_mfma_f32_32x32x4_2b_bf16 v[96:127], v[160:161], v[212:213], 0 cbsz:1 abid:1
    v_cvt_pk_bf16_f32 v129, v66, v67
    v_exp_f32 v68, v68
    v_exp_f32 v69, v69
    v_exp_f32 v70, v70
    v_cvt_pk_bf16_f32 v130, v68, v69
    v_exp_f32 v71, v71
    v_exp_f32 v72, v72
    v_cvt_pk_bf16_f32 v131, v70, v71
    v_exp_f32 v73, v73
    v_exp_f32 v74, v74
    v_cvt_pk_bf16_f32 v132, v72, v73
    s_add_u32 s57, s57, 5120
    v_exp_f32 v75, v75
    buffer_load_dwordx4 v243, s[8:11], s55 offen lds
    v_mfma_f32_32x32x16_bf16 v[48:63], v[192:195], v[140:143], v[48:63]
    v_cvt_pk_bf16_f32 v133, v74, v75
    v_exp_f32 v76, v76
    v_exp_f32 v77, v77
    v_exp_f32 v78, v78
    v_exp_f32 v79, v79
    s_add_u32 s55, s55, 40960
    v_cvt_pk_bf16_f32 v134, v76, v77
    v_cvt_pk_bf16_f32 v135, v78, v79
    v_mfma_f32_32x32x16_bf16 v[0:15], v[164:167], v[128:131], v[0:15]
    v_exp_f32 v80, v80
    v_exp_f32 v81, v81
    v_exp_f32 v82, v82
    v_cvt_pk_bf16_f32 v136, v80, v81
    s_mov_b64 exec, s[62:63]
    buffer_load_dwordx4 v[188:191], v242, s[12:15], s59 offen offset:1280 sc1
    buffer_load_dwordx4 v[192:195], v242, s[12:15], s59 offen offset:1920 sc1
    s_mov_b64 exec, -1
    v_exp_f32 v83, v83
    v_mfma_f32_32x32x16_bf16 v[96:111], v[148:151], v[196:199], v[96:111]
    v_cvt_pk_bf16_f32 v137, v82, v83
    v_exp_f32 v84, v84
    v_exp_f32 v85, v85
    v_exp_f32 v86, v86
    v_cvt_pk_bf16_f32 v138, v84, v85
    v_exp_f32 v87, v87
    v_mfma_f32_32x32x16_bf16 v[0:15], v[168:171], v[132:135], v[0:15]
    v_cvt_pk_bf16_f32 v139, v86, v87
    v_exp_f32 v88, v88
    v_exp_f32 v89, v89
    v_exp_f32 v90, v90
    v_cvt_pk_bf16_f32 v140, v88, v89
    v_exp_f32 v91, v91
    v_mfma_f32_32x32x16_bf16 v[112:127], v[148:151], v[200:203], v[112:127]
    v_cvt_pk_bf16_f32 v141, v90, v91
    v_exp_f32 v92, v92
    v_exp_f32 v93, v93
    v_exp_f32 v94, v94
    v_exp_f32 v95, v95
    v_cvt_pk_bf16_f32 v142, v92, v93
    v_cvt_pk_bf16_f32 v143, v94, v95
    s_waitcnt vmcnt(3)
    v_mfma_f32_32x32x16_bf16 v[16:31], v[164:167], v[136:139], v[16:31]
    v_exp_f32 v96, v96
    v_exp_f32 v97, v97
    v_exp_f32 v98, v98
    v_cvt_pk_bf16_f32 v128, v96, v97
    s_min_u32 s52, s57, 0x20000
    v_exp_f32 v99, v99
    s_add_u32 m0, s52, 61440
    v_mfma_f32_32x32x4_2b_bf16 v[64:95], v[162:163], v[212:213], 0 cbsz:1 abid:0
    v_cvt_pk_bf16_f32 v129, v98, v99
    v_exp_f32 v100, v100
    v_exp_f32 v101, v101
    v_exp_f32 v102, v102
    v_cvt_pk_bf16_f32 v130, v100, v101
    v_exp_f32 v103, v103
    v_exp_f32 v104, v104
    v_cvt_pk_bf16_f32 v131, v102, v103
    v_exp_f32 v105, v105
    v_exp_f32 v106, v106
    v_cvt_pk_bf16_f32 v132, v104, v105
    s_add_u32 s57, s57, 5120
    v_exp_f32 v107, v107
    buffer_load_dwordx4 v243, s[8:11], s55 offen lds
    v_mfma_f32_32x32x16_bf16 v[16:31], v[168:171], v[140:143], v[16:31]
    v_cvt_pk_bf16_f32 v133, v106, v107
    v_exp_f32 v108, v108
    v_exp_f32 v109, v109
    v_exp_f32 v110, v110
    v_exp_f32 v111, v111
    s_add_u32 s55, s55, 40960
    v_cvt_pk_bf16_f32 v134, v108, v109
    v_cvt_pk_bf16_f32 v135, v110, v111
    s_branch L_hL_24
L_hLb_25:
    v_mfma_f32_32x32x16_bf16 v[0:15], v[172:175], v[128:131], v[0:15]
    v_exp_f32 v112, v112
    v_exp_f32 v113, v113
    v_exp_f32 v114, v114
    v_cvt_pk_bf16_f32 v136, v112, v113
    v_exp_f32 v115, v115
    v_mfma_f32_32x32x16_bf16 v[64:79], v[152:155], v[196:199], v[64:79]
    v_cvt_pk_bf16_f32 v137, v114, v115
    v_exp_f32 v116, v116
    v_exp_f32 v117, v117
    v_exp_f32 v118, v118
    v_cvt_pk_bf16_f32 v138, v116, v117
    v_exp_f32 v119, v119
    v_mfma_f32_32x32x16_bf16 v[0:15], v[176:179], v[132:135], v[0:15]
    v_cvt_pk_bf16_f32 v139, v118, v119
    v_exp_f32 v120, v120
    v_exp_f32 v121, v121
    v_exp_f32 v122, v122
    v_cvt_pk_bf16_f32 v140, v120, v121
    v_exp_f32 v123, v123
    v_mfma_f32_32x32x16_bf16 v[80:95], v[152:155], v[200:203], v[80:95]
    v_cvt_pk_bf16_f32 v141, v122, v123
    v_exp_f32 v124, v124
    v_exp_f32 v125, v125
    v_exp_f32 v126, v126
    v_exp_f32 v127, v127
    v_cvt_pk_bf16_f32 v142, v124, v125
    v_cvt_pk_bf16_f32 v143, v126, v127
    v_mfma_f32_32x32x16_bf16 v[16:31], v[172:175], v[136:139], v[16:31]
    v_exp_f32 v64, v64
    v_exp_f32 v65, v65
    v_exp_f32 v66, v66
    v_cvt_pk_bf16_f32 v128, v64, v65
    v_exp_f32 v67, v67
    v_mfma_f32_32x32x4_2b_bf16 v[96:127], v[162:163], v[212:213], 0 cbsz:1 abid:1
    v_cvt_pk_bf16_f32 v129, v66, v67
    v_exp_f32 v68, v68
    v_exp_f32 v69, v69
    v_exp_f32 v70, v70
    v_cvt_pk_bf16_f32 v130, v68, v69
    v_exp_f32 v71, v71
    v_exp_f32 v72, v72
    v_cvt_pk_bf16_f32 v131, v70, v71
    v_exp_f32 v73, v73
    v_exp_f32 v74, v74
    v_cvt_pk_bf16_f32 v132, v72, v73
    v_exp_f32 v75, v75
    v_mfma_f32_32x32x16_bf16 v[16:31], v[176:179], v[140:143], v[16:31]
    v_cvt_pk_bf16_f32 v133, v74, v75
    v_exp_f32 v76, v76
    v_exp_f32 v77, v77
    v_exp_f32 v78, v78
    v_exp_f32 v79, v79
    v_cvt_pk_bf16_f32 v134, v76, v77
    v_cvt_pk_bf16_f32 v135, v78, v79
    v_mfma_f32_32x32x16_bf16 v[0:15], v[180:183], v[128:131], v[0:15]
    v_exp_f32 v80, v80
    v_exp_f32 v81, v81
    v_exp_f32 v82, v82
    v_cvt_pk_bf16_f32 v136, v80, v81
    v_exp_f32 v83, v83
    v_mfma_f32_32x32x16_bf16 v[96:111], v[156:159], v[196:199], v[96:111]
    v_cvt_pk_bf16_f32 v137, v82, v83
    v_exp_f32 v84, v84
    v_exp_f32 v85, v85
    v_exp_f32 v86, v86
    v_cvt_pk_bf16_f32 v138, v84, v85
    v_exp_f32 v87, v87
    v_mfma_f32_32x32x16_bf16 v[0:15], v[184:187], v[132:135], v[0:15]
    v_cvt_pk_bf16_f32 v139, v86, v87
    v_exp_f32 v88, v88
    v_exp_f32 v89, v89
    v_exp_f32 v90, v90
    v_cvt_pk_bf16_f32 v140, v88, v89
    v_exp_f32 v91, v91
    v_mfma_f32_32x32x16_bf16 v[112:127], v[156:159], v[200:203], v[112:127]
    v_cvt_pk_bf16_f32 v141, v90, v91
    v_exp_f32 v92, v92
    v_exp_f32 v93, v93
    v_exp_f32 v94, v94
    v_exp_f32 v95, v95
    v_cvt_pk_bf16_f32 v142, v92, v93
    v_cvt_pk_bf16_f32 v143, v94, v95
    v_mfma_f32_32x32x16_bf16 v[16:31], v[180:183], v[136:139], v[16:31]
    v_exp_f32 v96, v96
    v_exp_f32 v97, v97
    v_exp_f32 v98, v98
    v_cvt_pk_bf16_f32 v128, v96, v97
    v_exp_f32 v99, v99
    v_mfma_f32_32x32x4_2b_bf16 v[64:95], v[160:161], v[214:215], 0 cbsz:1 abid:0
    v_cvt_pk_bf16_f32 v129, v98, v99
    v_exp_f32 v100, v100
    v_exp_f32 v101, v101
    v_exp_f32 v102, v102
    v_cvt_pk_bf16_f32 v130, v100, v101
    v_exp_f32 v103, v103
    v_exp_f32 v104, v104
    v_cvt_pk_bf16_f32 v131, v102, v103
    v_exp_f32 v105, v105
    v_exp_f32 v106, v106
    v_cvt_pk_bf16_f32 v132, v104, v105
    v_exp_f32 v107, v107
    v_mfma_f32_32x32x16_bf16 v[16:31], v[184:187], v[140:143], v[16:31]
    v_cvt_pk_bf16_f32 v133, v106, v107
    v_exp_f32 v108, v108
    v_exp_f32 v109, v109
    v_exp_f32 v110, v110
    v_exp_f32 v111, v111
    v_cvt_pk_bf16_f32 v134, v108, v109
    v_cvt_pk_bf16_f32 v135, v110, v111
    s_waitcnt vmcnt(7)
    v_mfma_f32_32x32x16_bf16 v[0:15], v[188:191], v[128:131], v[0:15]
    v_exp_f32 v112, v112
    v_exp_f32 v113, v113
    v_exp_f32 v114, v114
    v_cvt_pk_bf16_f32 v136, v112, v113
    v_exp_f32 v115, v115
    v_mfma_f32_32x32x16_bf16 v[64:79], v[144:147], v[204:207], v[64:79]
    v_cvt_pk_bf16_f32 v137, v114, v115
    v_exp_f32 v116, v116
    v_exp_f32 v117, v117
    v_exp_f32 v118, v118
    v_cvt_pk_bf16_f32 v138, v116, v117
    v_exp_f32 v119, v119
    v_mfma_f32_32x32x16_bf16 v[0:15], v[192:195], v[132:135], v[0:15]
    v_cvt_pk_bf16_f32 v139, v118, v119
    v_exp_f32 v120, v120
    v_exp_f32 v121, v121
    v_exp_f32 v122, v122
    v_cvt_pk_bf16_f32 v140, v120, v121
    v_exp_f32 v123, v123
    v_mfma_f32_32x32x16_bf16 v[80:95], v[144:147], v[208:211], v[80:95]
    v_cvt_pk_bf16_f32 v141, v122, v123
    v_exp_f32 v124, v124
    v_exp_f32 v125, v125
    v_exp_f32 v126, v126
    v_exp_f32 v127, v127
    v_cvt_pk_bf16_f32 v142, v124, v125
    s_setprio 2
    v_cvt_pk_bf16_f32 v143, v126, v127
    v_mfma_f32_32x32x16_bf16 v[16:31], v[188:191], v[136:139], v[16:31]
    v_exp_f32 v64, v64
    v_exp_f32 v65, v65
    v_exp_f32 v66, v66
    v_cvt_pk_bf16_f32 v128, v64, v65
    v_exp_f32 v67, v67
    v_mfma_f32_32x32x4_2b_bf16 v[96:127], v[160:161], v[214:215], 0 cbsz:1 abid:1
    v_cvt_pk_bf16_f32 v129, v66, v67
    v_exp_f32 v68, v68
    v_exp_f32 v69, v69
    v_exp_f32 v70, v70
    v_cvt_pk_bf16_f32 v130, v68, v69
    v_exp_f32 v71, v71
    v_exp_f32 v72, v72
    v_cvt_pk_bf16_f32 v131, v70, v71
    v_exp_f32 v73, v73
    v_exp_f32 v74, v74
    v_cvt_pk_bf16_f32 v132, v72, v73
    v_exp_f32 v75, v75
    v_mfma_f32_32x32x16_bf16 v[16:31], v[192:195], v[140:143], v[16:31]
    v_cvt_pk_bf16_f32 v133, v74, v75
    v_exp_f32 v76, v76
    v_exp_f32 v77, v77
    v_exp_f32 v78, v78
    v_exp_f32 v79, v79
    v_cvt_pk_bf16_f32 v134, v76, v77
    v_cvt_pk_bf16_f32 v135, v78, v79
    v_mfma_f32_32x32x16_bf16 v[32:47], v[164:167], v[128:131], v[32:47]
    v_exp_f32 v80, v80
    v_exp_f32 v81, v81
    v_exp_f32 v82, v82
    v_cvt_pk_bf16_f32 v136, v80, v81
    ds_write_b128 v253, v[0:3] offset:0
    v_exp_f32 v83, v83
    ds_write_b128 v253, v[4:7] offset:1024
    v_mfma_f32_32x32x16_bf16 v[96:111], v[148:151], v[204:207], v[96:111]
    v_cvt_pk_bf16_f32 v137, v82, v83
    v_exp_f32 v84, v84
    v_exp_f32 v85, v85
    v_exp_f32 v86, v86
    v_cvt_pk_bf16_f32 v138, v84, v85
    ds_write_b128 v253, v[8:11] offset:2048
    v_exp_f32 v87, v87
    v_mfma_f32_32x32x16_bf16 v[32:47], v[168:171], v[132:135], v[32:47]
    v_cvt_pk_bf16_f32 v139, v86, v87
    v_exp_f32 v88, v88
    v_exp_f32 v89, v89
    v_exp_f32 v90, v90
    v_cvt_pk_bf16_f32 v140, v88, v89
    v_exp_f32 v91, v91
    v_mfma_f32_32x32x16_bf16 v[112:127], v[148:151], v[208:211], v[112:127]
    v_cvt_pk_bf16_f32 v141, v90, v91
    v_exp_f32 v92, v92
    v_exp_f32 v93, v93
    v_exp_f32 v94, v94
    v_exp_f32 v95, v95
    v_cvt_pk_bf16_f32 v142, v92, v93
    v_cvt_pk_bf16_f32 v143, v94, v95
    s_waitcnt vmcnt(6)
    v_mfma_f32_32x32x16_bf16 v[48:63], v[164:167], v[136:139], v[48:63]
    v_exp_f32 v96, v96
    v_exp_f32 v97, v97
    v_exp_f32 v98, v98
    v_cvt_pk_bf16_f32 v128, v96, v97
    ds_write_b128 v253, v[16:19] offset:3072
    v_exp_f32 v99, v99
    ds_write_b128 v253, v[20:23] offset:4096
    v_mfma_f32_32x32x4_2b_bf16 v[64:95], v[162:163], v[214:215], 0 cbsz:1 abid:0
    v_cvt_pk_bf16_f32 v129, v98, v99
    v_exp_f32 v100, v100
    v_exp_f32 v101, v101
    v_exp_f32 v102, v102
    v_cvt_pk_bf16_f32 v130, v100, v101
    v_exp_f32 v103, v103
    v_exp_f32 v104, v104
    v_cvt_pk_bf16_f32 v131, v102, v103
    v_exp_f32 v105, v105
    v_exp_f32 v106, v106
    v_cvt_pk_bf16_f32 v132, v104, v105
    ds_write_b128 v253, v[24:27] offset:5120
    v_exp_f32 v107, v107
    ds_write_b32 v246, v243 offset:57344
    v_mfma_f32_32x32x16_bf16 v[48:63], v[168:171], v[140:143], v[48:63]
    v_cvt_pk_bf16_f32 v133, v106, v107
    v_exp_f32 v108, v108
    v_exp_f32 v109, v109
    v_exp_f32 v110, v110
    v_exp_f32 v111, v111
    v_cvt_pk_bf16_f32 v134, v108, v109
    s_cmp_lg_u32 s58, 0
    s_cbranch_scc1 L_pr_37
    s_setprio 1
L_pr_37:
    v_cvt_pk_bf16_f32 v135, v110, v111
    v_mfma_f32_32x32x16_bf16 v[32:47], v[172:175], v[128:131], v[32:47]
    v_exp_f32 v112, v112
    v_exp_f32 v113, v113
    v_exp_f32 v114, v114
    v_cvt_pk_bf16_f32 v136, v112, v113
    v_exp_f32 v115, v115
    v_mfma_f32_32x32x16_bf16 v[64:79], v[152:155], v[204:207], v[64:79]
    v_cvt_pk_bf16_f32 v137, v114, v115
    v_exp_f32 v116, v116
    v_exp_f32 v117, v117
    v_exp_f32 v118, v118
    v_cvt_pk_bf16_f32 v138, v116, v117
    v_exp_f32 v119, v119
    v_mfma_f32_32x32x16_bf16 v[32:47], v[176:179], v[132:135], v[32:47]
    v_cvt_pk_bf16_f32 v139, v118, v119
    v_exp_f32 v120, v120
    v_exp_f32 v121, v121
    v_exp_f32 v122, v122
    v_cvt_pk_bf16_f32 v140, v120, v121
    v_exp_f32 v123, v123
    v_mfma_f32_32x32x16_bf16 v[80:95], v[152:155], v[208:211], v[80:95]
    v_cvt_pk_bf16_f32 v141, v122, v123
    v_exp_f32 v124, v124
    v_exp_f32 v125, v125
    v_exp_f32 v126, v126
    v_exp_f32 v127, v127
    v_cvt_pk_bf16_f32 v142, v124, v125
    v_cvt_pk_bf16_f32 v143, v126, v127
    v_mfma_f32_32x32x16_bf16 v[48:63], v[172:175], v[136:139], v[48:63]
    v_exp_f32 v64, v64
    v_exp_f32 v65, v65
    v_exp_f32 v66, v66
    v_cvt_pk_bf16_f32 v128, v64, v65
    v_exp_f32 v67, v67
    v_mfma_f32_32x32x4_2b_bf16 v[96:127], v[162:163], v[214:215], 0 cbsz:1 abid:1
    v_cvt_pk_bf16_f32 v129, v66, v67
    v_exp_f32 v68, v68
    v_exp_f32 v69, v69
    v_exp_f32 v70, v70
    v_cvt_pk_bf16_f32 v130, v68, v69
    v_exp_f32 v71, v71
    v_exp_f32 v72, v72
    v_cvt_pk_bf16_f32 v131, v70, v71
    v_exp_f32 v73, v73
    v_exp_f32 v74, v74
    v_cvt_pk_bf16_f32 v132, v72, v73
    v_exp_f32 v75, v75
    v_mfma_f32_32x32x16_bf16 v[48:63], v[176:179], v[140:143], v[48:63]
    v_cvt_pk_bf16_f32 v133, v74, v75
    v_exp_f32 v76, v76
    v_exp_f32 v77, v77
    v_exp_f32 v78, v78
    v_exp_f32 v79, v79
    v_cvt_pk_bf16_f32 v134, v76, v77
    s_setprio 1
    v_cvt_pk_bf16_f32 v135, v78, v79
    v_mfma_f32_32x32x16_bf16 v[32:47], v[180:183], v[128:131], v[32:47]
    v_exp_f32 v80, v80
    v_exp_f32 v81, v81
    v_exp_f32 v82, v82
    v_cvt_pk_bf16_f32 v136, v80, v81
    s_nop 0
    v_exp_f32 v83, v83
    s_nop 0
    v_mfma_f32_32x32x16_bf16 v[96:111], v[156:159], v[204:207], v[96:111]
    v_cvt_pk_bf16_f32 v137, v82, v83
    v_exp_f32 v84, v84
    v_exp_f32 v85, v85
    v_exp_f32 v86, v86
    v_cvt_pk_bf16_f32 v138, v84, v85
    ds_read_b32 v247, v244 offset:57344
    v_exp_f32 v87, v87
    v_mfma_f32_32x32x16_bf16 v[32:47], v[184:187], v[132:135], v[32:47]
    v_cvt_pk_bf16_f32 v139, v86, v87
    v_exp_f32 v88, v88
    v_exp_f32 v89, v89
    v_exp_f32 v90, v90
    v_cvt_pk_bf16_f32 v140, v88, v89
    v_exp_f32 v91, v91
    v_mfma_f32_32x32x16_bf16 v[112:127], v[156:159], v[208:211], v[112:127]
    v_cvt_pk_bf16_f32 v141, v90, v91
    v_exp_f32 v92, v92
    v_exp_f32 v93, v93
    v_exp_f32 v94, v94
    v_exp_f32 v95, v95
    v_cvt_pk_bf16_f32 v142, v92, v93
    v_cvt_pk_bf16_f32 v143, v94, v95
    s_waitcnt lgkmcnt(0)
    v_cmp_ne_u32 vcc, 1, v247
    s_cbranch_vccnz L_ps_35
L_pb_36:
    v_mfma_f32_32x32x16_bf16 v[48:63], v[180:183], v[136:139], v[48:63]
    v_exp_f32 v96, v96
    v_exp_f32 v97, v97
    v_exp_f32 v98, v98
    v_cvt_pk_bf16_f32 v128, v96, v97
    ds_read_b128 v[0:3], v254 offset:0
    v_exp_f32 v99, v99
    ds_read_b128 v[4:7], v254 offset:1024
    v_mfma_f32_32x32x16_bf16 v[48:63], v[184:187], v[140:143], v[48:63]
    v_cvt_pk_bf16_f32 v129, v98, v99
    v_exp_f32 v100, v100
    v_exp_f32 v101, v101
    v_exp_f32 v102, v102
    v_cvt_pk_bf16_f32 v130, v100, v101
    ds_read_b128 v[8:11], v254 offset:2048
    v_exp_f32 v103, v103
    ds_read_b128 v[16:19], v254 offset:3072
    v_exp_f32 v104, v104
    v_cvt_pk_bf16_f32 v131, v102, v103
    v_exp_f32 v105, v105
    v_exp_f32 v106, v106
    v_cvt_pk_bf16_f32 v132, v104, v105
    ds_read_b128 v[20:23], v254 offset:4096
    v_exp_f32 v107, v107
    ds_read_b128 v[24:27], v254 offset:5120
    v_exp_f32 v108, v108
    v_cvt_pk_bf16_f32 v133, v106, v107
    v_exp_f32 v109, v109
    v_exp_f32 v110, v110
    v_exp_f32 v111, v111
    v_cvt_pk_bf16_f32 v134, v108, v109
    v_cvt_pk_bf16_f32 v135, v110, v111
    v_mfma_f32_32x32x16_bf16 v[32:47], v[188:191], v[128:131], v[32:47]
    v_exp_f32 v112, v112
    v_exp_f32 v113, v113
    v_exp_f32 v114, v114
    v_cvt_pk_bf16_f32 v136, v112, v113
    v_exp_f32 v115, v115
    v_mfma_f32_32x32x16_bf16 v[32:47], v[192:195], v[132:135], v[32:47]
    v_cvt_pk_bf16_f32 v137, v114, v115
    v_exp_f32 v116, v116
    v_exp_f32 v117, v117
    v_exp_f32 v118, v118
    v_cvt_pk_bf16_f32 v138, v116, v117
    v_exp_f32 v119, v119
    v_exp_f32 v120, v120
    v_cvt_pk_bf16_f32 v139, v118, v119
    v_exp_f32 v121, v121
    v_exp_f32 v122, v122
    v_cvt_pk_bf16_f32 v140, v120, v121
    v_exp_f32 v123, v123
    v_exp_f32 v124, v124
    v_cvt_pk_bf16_f32 v141, v122, v123
    v_exp_f32 v125, v125
    v_exp_f32 v126, v126
    v_exp_f32 v127, v127
    v_cvt_pk_bf16_f32 v142, v124, v125
    v_cvt_pk_bf16_f32 v143, v126, v127
    s_nop 0
    v_mfma_f32_32x32x16_bf16 v[48:63], v[188:191], v[136:139], v[48:63]
    v_mfma_f32_32x32x16_bf16 v[48:63], v[192:195], v[140:143], v[48:63]
    s_waitcnt lgkmcnt(0)
    s_mov_b32 s51, 81920
    v_pk_add_f32 v[40:41], v[40:41], v[8:9]
    v_pk_add_f32 v[42:43], v[42:43], v[10:11]
    v_mov_b32 v44, v40
    v_mov_b32 v45, v40
    v_pk_add_f32 v[32:33], v[32:33], v[0:1]
    v_pk_add_f32 v[34:35], v[34:35], v[2:3]
    v_pk_add_f32 v[36:37], v[36:37], v[4:5]
    v_pk_add_f32 v[38:39], v[38:39], v[6:7]
    v_permlane32_swap_b32 v45, v44
    s_cmp_eq_u32 s34, 0
    v_rcp_f32 v46, v44
    s_nop 0
    v_pk_mul_f32 v[32:33], v[32:33], v[46:47] op_sel_hi:[1,0]
    v_pk_mul_f32 v[34:35], v[34:35], v[46:47] op_sel_hi:[1,0]
    v_pk_mul_f32 v[36:37], v[36:37], v[46:47] op_sel_hi:[1,0]
    v_pk_mul_f32 v[38:39], v[38:39], v[46:47] op_sel_hi:[1,0]
    v_pk_mul_f32 v[40:41], v[40:41], v[46:47] op_sel_hi:[1,0]
    v_pk_mul_f32 v[42:43], v[42:43], v[46:47] op_sel_hi:[1,0]
    v_cvt_pk_bf16_f32 v0, v32, v33
    v_cvt_pk_bf16_f32 v1, v34, v35
    v_cvt_pk_bf16_f32 v2, v36, v37
    v_cvt_pk_bf16_f32 v3, v38, v39
    v_cvt_pk_bf16_f32 v4, v40, v41
    v_cvt_pk_bf16_f32 v5, v42, v43
    s_cbranch_scc1 L_fs_43
    buffer_store_dwordx4 v[0:3], v225, s[40:43], 0 offen
    buffer_store_dwordx2 v[4:5], v226, s[40:43], 0 offen
    s_branch L_fs_44
L_fs_43:
    buffer_store_dwordx4 v[0:3], v225, s[40:43], 0 offen sc1
    buffer_store_dwordx2 v[4:5], v226, s[40:43], 0 offen sc1
L_fs_44:
    v_pk_add_f32 v[56:57], v[56:57], v[24:25]
    v_pk_add_f32 v[58:59], v[58:59], v[26:27]
    v_mov_b32 v60, v56
    v_mov_b32 v61, v56
    v_pk_add_f32 v[48:49], v[48:49], v[16:17]
    v_pk_add_f32 v[50:51], v[50:51], v[18:19]
    v_pk_add_f32 v[52:53], v[52:53], v[20:21]
    v_pk_add_f32 v[54:55], v[54:55], v[22:23]
    v_permlane32_swap_b32 v61, v60
    s_cmp_eq_u32 s34, 0
    v_rcp_f32 v62, v60
    s_nop 0
    v_pk_mul_f32 v[48:49], v[48:49], v[62:63] op_sel_hi:[1,0]
    v_pk_mul_f32 v[50:51], v[50:51], v[62:63] op_sel_hi:[1,0]
    v_pk_mul_f32 v[52:53], v[52:53], v[62:63] op_sel_hi:[1,0]
    v_pk_mul_f32 v[54:55], v[54:55], v[62:63] op_sel_hi:[1,0]
    v_pk_mul_f32 v[56:57], v[56:57], v[62:63] op_sel_hi:[1,0]
    v_pk_mul_f32 v[58:59], v[58:59], v[62:63] op_sel_hi:[1,0]
    v_cvt_pk_bf16_f32 v16, v48, v49
    v_cvt_pk_bf16_f32 v17, v50, v51
    v_cvt_pk_bf16_f32 v18, v52, v53
    v_cvt_pk_bf16_f32 v19, v54, v55
    v_cvt_pk_bf16_f32 v20, v56, v57
    v_cvt_pk_bf16_f32 v21, v58, v59
    s_cbranch_scc1 L_fs_45
    buffer_store_dwordx4 v[16:19], v225, s[40:43], s51 offen
    buffer_store_dwordx2 v[20:21], v226, s[40:43], s51 offen
    s_branch L_fs_46
L_fs_45:
    buffer_store_dwordx4 v[16:19], v225, s[40:43], s51 offen sc1
    buffer_store_dwordx2 v[20:21], v226, s[40:43], s51 offen sc1
L_fs_46:
    s_setprio 0
L_oj_39:
    s_mov_b32 s50, 0x2b800000
    s_mov_b32 s51, 0x5d800000
    v_pk_mul_f32 v[46:47], v[32:33], 0 op_sel_hi:[1,0]
    v_pk_mul_f32 v[62:63], v[48:49], 0 op_sel_hi:[1,0]
    v_pk_fma_f32 v[46:47], v[34:35], 0, v[46:47] op_sel_hi:[1,0,1]
    v_pk_fma_f32 v[62:63], v[50:51], 0, v[62:63] op_sel_hi:[1,0,1]
    v_pk_fma_f32 v[46:47], v[36:37], 0, v[46:47] op_sel_hi:[1,0,1]
    v_pk_fma_f32 v[62:63], v[52:53], 0, v[62:63] op_sel_hi:[1,0,1]
    v_pk_fma_f32 v[46:47], v[38:39], 0, v[46:47] op_sel_hi:[1,0,1]
    v_pk_fma_f32 v[62:63], v[54:55], 0, v[62:63] op_sel_hi:[1,0,1]
    v_pk_fma_f32 v[46:47], v[40:41], 0, v[46:47] op_sel_hi:[1,0,1]
    v_pk_fma_f32 v[62:63], v[56:57], 0, v[62:63] op_sel_hi:[1,0,1]
    v_pk_fma_f32 v[46:47], v[42:43], 0, v[46:47] op_sel_hi:[1,0,1]
    v_pk_fma_f32 v[62:63], v[58:59], 0, v[62:63] op_sel_hi:[1,0,1]
    v_min_f32 v247, v44, v60
    v_max_f32 v248, v44, v60
    v_cmp_o_f32 vcc, v46, v47
    v_cmp_o_f32 s[16:17], v62, v63
    v_cmp_le_f32 s[18:19], s50, v247
    v_cmp_ge_f32 s[22:23], s51, v248
    s_and_b64 vcc, vcc, s[16:17]
    s_and_b64 s[18:19], s[18:19], s[22:23]
    s_and_b64 vcc, vcc, s[18:19]
    s_cmp_eq_u64 vcc, -1
    s_cbranch_scc0 L_slow_33
L_ok_42:
    s_cmp_lg_u32 s58, 0
    s_cbranch_scc1 L_sk_48
    ds_read_b64_tr_b16 v[76:77], v220 offset:5120
    ds_read_b64_tr_b16 v[78:79], v220 offset:6400
    ds_read_b64_tr_b16 v[80:81], v221 offset:5120
    ds_read_b64_tr_b16 v[82:83], v221 offset:6400
    ds_read_b64_tr_b16 v[84:85], v222 offset:5120
    ds_read_b64_tr_b16 v[86:87], v222 offset:6400
    ds_read_b64_tr_b16 v[88:89], v223 offset:5120
    ds_read_b64_tr_b16 v[90:91], v223 offset:6400
    ds_read_b64_tr_b16 v[92:93], v224 offset:5120
    ds_read_b64_tr_b16 v[94:95], v224 offset:6400
    ds_read_b64_tr_b16 v[96:97], v220 offset:10240
    ds_read_b64_tr_b16 v[98:99], v220 offset:11520
    ds_read_b64_tr_b16 v[100:101], v221 offset:10240
    ds_read_b64_tr_b16 v[102:103], v221 offset:11520
    ds_read_b64_tr_b16 v[104:105], v222 offset:10240
    ds_read_b64_tr_b16 v[106:107], v222 offset:11520
    ds_read_b64_tr_b16 v[108:109], v223 offset:10240
    ds_read_b64_tr_b16 v[110:111], v223 offset:11520
    ds_read_b64_tr_b16 v[112:113], v224 offset:10240
    ds_read_b64_tr_b16 v[114:115], v224 offset:11520
    ds_read_b64_tr_b16 v[116:117], v220 offset:15360
    ds_read_b64_tr_b16 v[118:119], v220 offset:16640
    ds_read_b64_tr_b16 v[120:121], v221 offset:15360
    ds_read_b64_tr_b16 v[122:123], v221 offset:16640
    ds_read_b64_tr_b16 v[124:125], v222 offset:15360
    ds_read_b64_tr_b16 v[126:127], v222 offset:16640
    ds_read_b64_tr_b16 v[128:129], v223 offset:15360
    ds_read_b64_tr_b16 v[130:131], v223 offset:16640
    ds_read_b64_tr_b16 v[132:133], v224 offset:15360
    ds_read_b64_tr_b16 v[134:135], v224 offset:16640
    s_lshl2_add_u32 s50, s45, s61
    s_mul_i32 s50, s50, 81920
    s_mul_i32 s51, s44, 1280
    s_add_u32 s50, s50, s51
    s_mul_i32 s51, s46, 160
    s_add_u32 s50, s50, s51
    s_add_u32 s12, s28, s50
    s_addc_u32 s13, s29, 0
    s_mov_b32 s14, 79520
    s_mov_b32 s15, 0x00020000
L_sk_48:
    s_cmp_eq_u32 s34, 0
    s_waitcnt vmcnt(0)
    s_cbranch_scc1 L_o2_40
    s_mov_b64 exec, 1
    buffer_store_dword v252, v251, s[36:39], s60 offen
    s_mov_b64 exec, -1
    s_branch L_o3_41
L_o2_40:
    s_mov_b32 exec_hi, 0
    buffer_store_dword v252, v251, s[36:39], s60 offen sc1
    s_mov_b64 exec, -1
L_o3_41:
    s_cmp_lg_u32 s58, 0
    s_cbranch_scc1 L_fin_47
    ds_read_b64_tr_b16 v[56:57], v220 offset:0
    ds_read_b64_tr_b16 v[58:59], v220 offset:1280
    ds_read_b64_tr_b16 v[60:61], v221 offset:0
    ds_read_b64_tr_b16 v[62:63], v221 offset:1280
    ds_read_b64_tr_b16 v[64:65], v222 offset:0
    ds_read_b64_tr_b16 v[66:67], v222 offset:1280
    ds_read_b64_tr_b16 v[68:69], v223 offset:0
    ds_read_b64_tr_b16 v[70:71], v223 offset:1280
    ds_read_b64_tr_b16 v[72:73], v224 offset:0
    ds_read_b64_tr_b16 v[74:75], v224 offset:1280
    ds_read_b64_tr_b16 v[136:137], v220 offset:20480
    ds_read_b64_tr_b16 v[138:139], v220 offset:21760
    ds_read_b64_tr_b16 v[140:141], v221 offset:20480
    ds_read_b64_tr_b16 v[142:143], v221 offset:21760
    ds_read_b64_tr_b16 v[144:145], v222 offset:20480
    ds_read_b64_tr_b16 v[146:147], v222 offset:21760
    ds_read_b64_tr_b16 v[148:149], v223 offset:20480
    ds_read_b64_tr_b16 v[150:151], v223 offset:21760
    ds_read_b64_tr_b16 v[152:153], v224 offset:20480
    ds_read_b64_tr_b16 v[154:155], v224 offset:21760
    ds_read_b64_tr_b16 v[156:157], v220 offset:25600
    ds_read_b64_tr_b16 v[158:159], v220 offset:26880
    ds_read_b64_tr_b16 v[160:161], v221 offset:25600
    ds_read_b64_tr_b16 v[162:163], v221 offset:26880
    ds_read_b64_tr_b16 v[164:165], v222 offset:25600
    ds_read_b64_tr_b16 v[166:167], v222 offset:26880
    ds_read_b64_tr_b16 v[168:169], v223 offset:25600
    ds_read_b64_tr_b16 v[170:171], v223 offset:26880
    ds_read_b64_tr_b16 v[172:173], v224 offset:25600
    ds_read_b64_tr_b16 v[174:175], v224 offset:26880
    s_mov_b32 s52, 100000
L_poll_49:
    buffer_load_dword v247, v227, s[36:39], s54 offen sc1
    s_waitcnt vmcnt(0)
    v_cmp_ne_u32 vcc, s48, v247
    s_cbranch_vccz L_polld_50
    s_sub_u32 s52, s52, 1
    s_cbranch_scc1 L_polld_50
    s_sleep 2
    s_branch L_poll_49
L_polld_50:
    s_mov_b32 s50, 0
    s_mov_b32 s51, 40960
    buffer_load_dwordx4 v[0:3], v216, s[4:7], s50 offen sc1
    buffer_load_dwordx4 v[4:7], v216, s[4:7], s51 offen sc1
    buffer_load_dwordx4 v[8:11], v217, s[4:7], s50 offen sc1
    buffer_load_dwordx4 v[12:15], v217, s[4:7], s51 offen sc1
    buffer_load_dwordx4 v[16:19], v218, s[4:7], s50 offen sc1
    buffer_load_dwordx4 v[20:23], v218, s[4:7], s51 offen sc1
    s_waitcnt vmcnt(4) lgkmcnt(0)
    v_mfma_f32_16x16x32_bf16 v[176:179], v[56:59], v[0:3], 0
    buffer_load_dwordx4 v[24:27], v219, s[4:7], s50 offen sc1
    v_mfma_f32_16x16x32_bf16 v[196:199], v[56:59], v[4:7], 0
    buffer_load_dwordx4 v[28:31], v219, s[4:7], s51 offen sc1
    v_mfma_f32_16x16x32_bf16 v[180:183], v[60:63], v[0:3], 0
    v_mfma_f32_16x16x32_bf16 v[200:203], v[60:63], v[4:7], 0
    v_mfma_f32_16x16x32_bf16 v[184:187], v[64:67], v[0:3], 0
    v_mfma_f32_16x16x32_bf16 v[204:207], v[64:67], v[4:7], 0
    v_mfma_f32_16x16x32_bf16 v[188:191], v[68:71], v[0:3], 0
    v_mfma_f32_16x16x32_bf16 v[208:211], v[68:71], v[4:7], 0
    v_mfma_f32_16x16x32_bf16 v[192:195], v[72:75], v[0:3], 0
    v_mfma_f32_16x16x32_bf16 v[212:215], v[72:75], v[4:7], 0
    s_waitcnt vmcnt(4) lgkmcnt(14)
    v_mfma_f32_16x16x32_bf16 v[176:179], v[76:79], v[8:11], v[176:179]
    buffer_load_dwordx4 v[32:35], v228, s[4:7], s50 offen sc1
    v_mfma_f32_16x16x32_bf16 v[196:199], v[76:79], v[12:15], v[196:199]
    ds_read_b64_tr_b16 v[56:57], v220 offset:30720
    v_mfma_f32_16x16x32_bf16 v[180:183], v[80:83], v[8:11], v[180:183]
    ds_read_b64_tr_b16 v[58:59], v220 offset:32000
    v_mfma_f32_16x16x32_bf16 v[200:203], v[80:83], v[12:15], v[200:203]
    ds_read_b64_tr_b16 v[60:61], v221 offset:30720
    v_mfma_f32_16x16x32_bf16 v[184:187], v[84:87], v[8:11], v[184:187]
    ds_read_b64_tr_b16 v[62:63], v221 offset:32000
    v_mfma_f32_16x16x32_bf16 v[204:207], v[84:87], v[12:15], v[204:207]
    buffer_load_dwordx4 v[36:39], v228, s[4:7], s51 offen sc1
    v_mfma_f32_16x16x32_bf16 v[188:191], v[88:91], v[8:11], v[188:191]
    ds_read_b64_tr_b16 v[64:65], v222 offset:30720
    v_mfma_f32_16x16x32_bf16 v[208:211], v[88:91], v[12:15], v[208:211]
    ds_read_b64_tr_b16 v[66:67], v222 offset:32000
    v_mfma_f32_16x16x32_bf16 v[192:195], v[92:95], v[8:11], v[192:195]
    ds_read_b64_tr_b16 v[68:69], v223 offset:30720
    v_mfma_f32_16x16x32_bf16 v[212:215], v[92:95], v[12:15], v[212:215]
    ds_read_b64_tr_b16 v[70:71], v223 offset:32000
    ds_read_b64_tr_b16 v[72:73], v224 offset:30720
    s_waitcnt vmcnt(4) lgkmcnt(14)
    v_mfma_f32_16x16x32_bf16 v[176:179], v[96:99], v[16:19], v[176:179]
    s_mov_b32 s50, 10240
    s_mov_b32 s51, 51200
    buffer_load_dwordx4 v[40:43], v216, s[4:7], s50 offen sc1
    v_mfma_f32_16x16x32_bf16 v[196:199], v[96:99], v[20:23], v[196:199]
    ds_read_b64_tr_b16 v[74:75], v224 offset:32000
    v_mfma_f32_16x16x32_bf16 v[180:183], v[100:103], v[16:19], v[180:183]
    ds_read_b64_tr_b16 v[76:77], v220 offset:35840
    v_mfma_f32_16x16x32_bf16 v[200:203], v[100:103], v[20:23], v[200:203]
    ds_read_b64_tr_b16 v[78:79], v220 offset:37120
    v_mfma_f32_16x16x32_bf16 v[184:187], v[104:107], v[16:19], v[184:187]
    ds_read_b64_tr_b16 v[80:81], v221 offset:35840
    v_mfma_f32_16x16x32_bf16 v[204:207], v[104:107], v[20:23], v[204:207]
    buffer_load_dwordx4 v[44:47], v216, s[4:7], s51 offen sc1
    v_mfma_f32_16x16x32_bf16 v[188:191], v[108:111], v[16:19], v[188:191]
    ds_read_b64_tr_b16 v[82:83], v221 offset:37120
    v_mfma_f32_16x16x32_bf16 v[208:211], v[108:111], v[20:23], v[208:211]
    ds_read_b64_tr_b16 v[84:85], v222 offset:35840
    v_mfma_f32_16x16x32_bf16 v[192:195], v[112:115], v[16:19], v[192:195]
    ds_read_b64_tr_b16 v[86:87], v222 offset:37120
    v_mfma_f32_16x16x32_bf16 v[212:215], v[112:115], v[20:23], v[212:215]
    ds_read_b64_tr_b16 v[88:89], v223 offset:35840
    ds_read_b64_tr_b16 v[90:91], v223 offset:37120
    s_waitcnt vmcnt(4) lgkmcnt(14)
    v_mfma_f32_16x16x32_bf16 v[176:179], v[116:119], v[24:27], v[176:179]
    buffer_load_dwordx4 v[48:51], v217, s[4:7], s50 offen sc1
    v_mfma_f32_16x16x32_bf16 v[196:199], v[116:119], v[28:31], v[196:199]
    ds_read_b64_tr_b16 v[92:93], v224 offset:35840
    v_mfma_f32_16x16x32_bf16 v[180:183], v[120:123], v[24:27], v[180:183]
    ds_read_b64_tr_b16 v[94:95], v224 offset:37120
    v_mfma_f32_16x16x32_bf16 v[200:203], v[120:123], v[28:31], v[200:203]
    ds_read_b64_tr_b16 v[96:97], v220 offset:40960
    v_mfma_f32_16x16x32_bf16 v[184:187], v[124:127], v[24:27], v[184:187]
    ds_read_b64_tr_b16 v[98:99], v220 offset:42240
    v_mfma_f32_16x16x32_bf16 v[204:207], v[124:127], v[28:31], v[204:207]
    buffer_load_dwordx4 v[52:55], v217, s[4:7], s51 offen sc1
    v_mfma_f32_16x16x32_bf16 v[188:191], v[128:131], v[24:27], v[188:191]
    ds_read_b64_tr_b16 v[100:101], v221 offset:40960
    v_mfma_f32_16x16x32_bf16 v[208:211], v[128:131], v[28:31], v[208:211]
    ds_read_b64_tr_b16 v[102:103], v221 offset:42240
    v_mfma_f32_16x16x32_bf16 v[192:195], v[132:135], v[24:27], v[192:195]
    ds_read_b64_tr_b16 v[104:105], v222 offset:40960
    v_mfma_f32_16x16x32_bf16 v[212:215], v[132:135], v[28:31], v[212:215]
    ds_read_b64_tr_b16 v[106:107], v222 offset:42240
    ds_read_b64_tr_b16 v[108:109], v223 offset:40960
    s_waitcnt vmcnt(4) lgkmcnt(14)
    v_mfma_f32_16x16x32_bf16 v[176:179], v[136:139], v[32:35], v[176:179]
    buffer_load_dwordx4 v[0:3], v218, s[4:7], s50 offen sc1
    v_mfma_f32_16x16x32_bf16 v[196:199], v[136:139], v[36:39], v[196:199]
    ds_read_b64_tr_b16 v[110:111], v223 offset:42240
    v_mfma_f32_16x16x32_bf16 v[180:183], v[140:143], v[32:35], v[180:183]
    ds_read_b64_tr_b16 v[112:113], v224 offset:40960
    v_mfma_f32_16x16x32_bf16 v[200:203], v[140:143], v[36:39], v[200:203]
    ds_read_b64_tr_b16 v[114:115], v224 offset:42240
    v_mfma_f32_16x16x32_bf16 v[184:187], v[144:147], v[32:35], v[184:187]
    ds_read_b64_tr_b16 v[116:117], v220 offset:46080
    v_mfma_f32_16x16x32_bf16 v[204:207], v[144:147], v[36:39], v[204:207]
    buffer_load_dwordx4 v[4:7], v218, s[4:7], s51 offen sc1
    v_mfma_f32_16x16x32_bf16 v[188:191], v[148:151], v[32:35], v[188:191]
    ds_read_b64_tr_b16 v[118:119], v220 offset:47360
    v_mfma_f32_16x16x32_bf16 v[208:211], v[148:151], v[36:39], v[208:211]
    ds_read_b64_tr_b16 v[120:121], v221 offset:46080
    v_mfma_f32_16x16x32_bf16 v[192:195], v[152:155], v[32:35], v[192:195]
    ds_read_b64_tr_b16 v[122:123], v221 offset:47360
    v_mfma_f32_16x16x32_bf16 v[212:215], v[152:155], v[36:39], v[212:215]
    ds_read_b64_tr_b16 v[124:125], v222 offset:46080
    ds_read_b64_tr_b16 v[126:127], v222 offset:47360
    s_waitcnt vmcnt(4) lgkmcnt(14)
    v_mfma_f32_16x16x32_bf16 v[176:179], v[156:159], v[40:43], v[176:179]
    buffer_load_dwordx4 v[8:11], v219, s[4:7], s50 offen sc1
    v_mfma_f32_16x16x32_bf16 v[196:199], v[156:159], v[44:47], v[196:199]
    ds_read_b64_tr_b16 v[128:129], v223 offset:46080
    v_mfma_f32_16x16x32_bf16 v[180:183], v[160:163], v[40:43], v[180:183]
    ds_read_b64_tr_b16 v[130:131], v223 offset:47360
    v_mfma_f32_16x16x32_bf16 v[200:203], v[160:163], v[44:47], v[200:203]
    ds_read_b64_tr_b16 v[132:133], v224 offset:46080
    v_mfma_f32_16x16x32_bf16 v[184:187], v[164:167], v[40:43], v[184:187]
    ds_read_b64_tr_b16 v[134:135], v224 offset:47360
    v_mfma_f32_16x16x32_bf16 v[204:207], v[164:167], v[44:47], v[204:207]
    buffer_load_dwordx4 v[12:15], v219, s[4:7], s51 offen sc1
    v_mfma_f32_16x16x32_bf16 v[188:191], v[168:171], v[40:43], v[188:191]
    ds_read_b64_tr_b16 v[136:137], v220 offset:51200
    v_mfma_f32_16x16x32_bf16 v[208:211], v[168:171], v[44:47], v[208:211]
    ds_read_b64_tr_b16 v[138:139], v220 offset:52480
    v_mfma_f32_16x16x32_bf16 v[192:195], v[172:175], v[40:43], v[192:195]
    ds_read_b64_tr_b16 v[140:141], v221 offset:51200
    v_mfma_f32_16x16x32_bf16 v[212:215], v[172:175], v[44:47], v[212:215]
    ds_read_b64_tr_b16 v[142:143], v221 offset:52480
    ds_read_b64_tr_b16 v[144:145], v222 offset:51200
    s_waitcnt vmcnt(4) lgkmcnt(14)
    v_mfma_f32_16x16x32_bf16 v[176:179], v[56:59], v[48:51], v[176:179]
    buffer_load_dwordx4 v[16:19], v228, s[4:7], s50 offen sc1
    v_mfma_f32_16x16x32_bf16 v[196:199], v[56:59], v[52:55], v[196:199]
    ds_read_b64_tr_b16 v[146:147], v222 offset:52480
    v_mfma_f32_16x16x32_bf16 v[180:183], v[60:63], v[48:51], v[180:183]
    ds_read_b64_tr_b16 v[148:149], v223 offset:51200
    v_mfma_f32_16x16x32_bf16 v[200:203], v[60:63], v[52:55], v[200:203]
    ds_read_b64_tr_b16 v[150:151], v223 offset:52480
    v_mfma_f32_16x16x32_bf16 v[184:187], v[64:67], v[48:51], v[184:187]
    ds_read_b64_tr_b16 v[152:153], v224 offset:51200
    v_mfma_f32_16x16x32_bf16 v[204:207], v[64:67], v[52:55], v[204:207]
    buffer_load_dwordx4 v[20:23], v228, s[4:7], s51 offen sc1
    v_mfma_f32_16x16x32_bf16 v[188:191], v[68:71], v[48:51], v[188:191]
    ds_read_b64_tr_b16 v[154:155], v224 offset:52480
    v_mfma_f32_16x16x32_bf16 v[208:211], v[68:71], v[52:55], v[208:211]
    ds_read_b64_tr_b16 v[156:157], v220 offset:56320
    v_mfma_f32_16x16x32_bf16 v[192:195], v[72:75], v[48:51], v[192:195]
    ds_read_b64_tr_b16 v[158:159], v220 offset:57600
    v_mfma_f32_16x16x32_bf16 v[212:215], v[72:75], v[52:55], v[212:215]
    ds_read_b64_tr_b16 v[160:161], v221 offset:56320
    ds_read_b64_tr_b16 v[162:163], v221 offset:57600
    s_waitcnt vmcnt(4) lgkmcnt(14)
    v_mfma_f32_16x16x32_bf16 v[176:179], v[76:79], v[0:3], v[176:179]
    s_mov_b32 s50, 20480
    s_mov_b32 s51, 61440
    buffer_load_dwordx4 v[24:27], v216, s[4:7], s50 offen sc1
    v_mfma_f32_16x16x32_bf16 v[196:199], v[76:79], v[4:7], v[196:199]
    ds_read_b64_tr_b16 v[164:165], v222 offset:56320
    v_mfma_f32_16x16x32_bf16 v[180:183], v[80:83], v[0:3], v[180:183]
    ds_read_b64_tr_b16 v[166:167], v222 offset:57600
    v_mfma_f32_16x16x32_bf16 v[200:203], v[80:83], v[4:7], v[200:203]
    ds_read_b64_tr_b16 v[168:169], v223 offset:56320
    v_mfma_f32_16x16x32_bf16 v[184:187], v[84:87], v[0:3], v[184:187]
    ds_read_b64_tr_b16 v[170:171], v223 offset:57600
    v_mfma_f32_16x16x32_bf16 v[204:207], v[84:87], v[4:7], v[204:207]
    buffer_load_dwordx4 v[28:31], v216, s[4:7], s51 offen sc1
    v_mfma_f32_16x16x32_bf16 v[188:191], v[88:91], v[0:3], v[188:191]
    ds_read_b64_tr_b16 v[172:173], v224 offset:56320
    v_mfma_f32_16x16x32_bf16 v[208:211], v[88:91], v[4:7], v[208:211]
    ds_read_b64_tr_b16 v[174:175], v224 offset:57600
    v_mfma_f32_16x16x32_bf16 v[192:195], v[92:95], v[0:3], v[192:195]
    v_add_u32 v220, 61440, v220
    v_add_u32 v221, 61440, v221
    v_add_u32 v222, 61440, v222
    v_add_u32 v223, 61440, v223
    v_add_u32 v224, 61440, v224
    ds_read_b64_tr_b16 v[56:57], v220 offset:0
    v_mfma_f32_16x16x32_bf16 v[212:215], v[92:95], v[4:7], v[212:215]
    ds_read_b64_tr_b16 v[58:59], v220 offset:1280
    ds_read_b64_tr_b16 v[60:61], v221 offset:0
    s_waitcnt vmcnt(4) lgkmcnt(14)
    v_mfma_f32_16x16x32_bf16 v[176:179], v[96:99], v[8:11], v[176:179]
    buffer_load_dwordx4 v[32:35], v217, s[4:7], s50 offen sc1
    v_mfma_f32_16x16x32_bf16 v[196:199], v[96:99], v[12:15], v[196:199]
    ds_read_b64_tr_b16 v[62:63], v221 offset:1280
    v_mfma_f32_16x16x32_bf16 v[180:183], v[100:103], v[8:11], v[180:183]
    ds_read_b64_tr_b16 v[64:65], v222 offset:0
    v_mfma_f32_16x16x32_bf16 v[200:203], v[100:103], v[12:15], v[200:203]
    ds_read_b64_tr_b16 v[66:67], v222 offset:1280
    v_mfma_f32_16x16x32_bf16 v[184:187], v[104:107], v[8:11], v[184:187]
    ds_read_b64_tr_b16 v[68:69], v223 offset:0
    v_mfma_f32_16x16x32_bf16 v[204:207], v[104:107], v[12:15], v[204:207]
    buffer_load_dwordx4 v[36:39], v217, s[4:7], s51 offen sc1
    v_mfma_f32_16x16x32_bf16 v[188:191], v[108:111], v[8:11], v[188:191]
    ds_read_b64_tr_b16 v[70:71], v223 offset:1280
    v_mfma_f32_16x16x32_bf16 v[208:211], v[108:111], v[12:15], v[208:211]
    ds_read_b64_tr_b16 v[72:73], v224 offset:0
    v_mfma_f32_16x16x32_bf16 v[192:195], v[112:115], v[8:11], v[192:195]
    ds_read_b64_tr_b16 v[74:75], v224 offset:1280
    v_mfma_f32_16x16x32_bf16 v[212:215], v[112:115], v[12:15], v[212:215]
    ds_read_b64_tr_b16 v[76:77], v220 offset:5120
    ds_read_b64_tr_b16 v[78:79], v220 offset:6400
    s_waitcnt vmcnt(4) lgkmcnt(14)
    v_mfma_f32_16x16x32_bf16 v[176:179], v[116:119], v[16:19], v[176:179]
    buffer_load_dwordx4 v[40:43], v218, s[4:7], s50 offen sc1
    v_mfma_f32_16x16x32_bf16 v[196:199], v[116:119], v[20:23], v[196:199]
    ds_read_b64_tr_b16 v[80:81], v221 offset:5120
    v_mfma_f32_16x16x32_bf16 v[180:183], v[120:123], v[16:19], v[180:183]
    ds_read_b64_tr_b16 v[82:83], v221 offset:6400
    v_mfma_f32_16x16x32_bf16 v[200:203], v[120:123], v[20:23], v[200:203]
    ds_read_b64_tr_b16 v[84:85], v222 offset:5120
    v_mfma_f32_16x16x32_bf16 v[184:187], v[124:127], v[16:19], v[184:187]
    ds_read_b64_tr_b16 v[86:87], v222 offset:6400
    v_mfma_f32_16x16x32_bf16 v[204:207], v[124:127], v[20:23], v[204:207]
    buffer_load_dwordx4 v[44:47], v218, s[4:7], s51 offen sc1
    v_mfma_f32_16x16x32_bf16 v[188:191], v[128:131], v[16:19], v[188:191]
    ds_read_b64_tr_b16 v[88:89], v223 offset:5120
    v_mfma_f32_16x16x32_bf16 v[208:211], v[128:131], v[20:23], v[208:211]
    ds_read_b64_tr_b16 v[90:91], v223 offset:6400
    v_mfma_f32_16x16x32_bf16 v[192:195], v[132:135], v[16:19], v[192:195]
    ds_read_b64_tr_b16 v[92:93], v224 offset:5120
    v_mfma_f32_16x16x32_bf16 v[212:215], v[132:135], v[20:23], v[212:215]
    ds_read_b64_tr_b16 v[94:95], v224 offset:6400
    ds_read_b64_tr_b16 v[96:97], v220 offset:10240
    s_waitcnt vmcnt(4) lgkmcnt(14)
    v_mfma_f32_16x16x32_bf16 v[176:179], v[136:139], v[24:27], v[176:179]
    buffer_load_dwordx4 v[48:51], v219, s[4:7], s50 offen sc1
    v_mfma_f32_16x16x32_bf16 v[196:199], v[136:139], v[28:31], v[196:199]
    ds_read_b64_tr_b16 v[98:99], v220 offset:11520
    v_mfma_f32_16x16x32_bf16 v[180:183], v[140:143], v[24:27], v[180:183]
    ds_read_b64_tr_b16 v[100:101], v221 offset:10240
    v_mfma_f32_16x16x32_bf16 v[200:203], v[140:143], v[28:31], v[200:203]
    ds_read_b64_tr_b16 v[102:103], v221 offset:11520
    v_mfma_f32_16x16x32_bf16 v[184:187], v[144:147], v[24:27], v[184:187]
    ds_read_b64_tr_b16 v[104:105], v222 offset:10240
    v_mfma_f32_16x16x32_bf16 v[204:207], v[144:147], v[28:31], v[204:207]
    buffer_load_dwordx4 v[52:55], v219, s[4:7], s51 offen sc1
    v_mfma_f32_16x16x32_bf16 v[188:191], v[148:151], v[24:27], v[188:191]
    ds_read_b64_tr_b16 v[106:107], v222 offset:11520
    v_mfma_f32_16x16x32_bf16 v[208:211], v[148:151], v[28:31], v[208:211]
    ds_read_b64_tr_b16 v[108:109], v223 offset:10240
    v_mfma_f32_16x16x32_bf16 v[192:195], v[152:155], v[24:27], v[192:195]
    ds_read_b64_tr_b16 v[110:111], v223 offset:11520
    v_mfma_f32_16x16x32_bf16 v[212:215], v[152:155], v[28:31], v[212:215]
    ds_read_b64_tr_b16 v[112:113], v224 offset:10240
    ds_read_b64_tr_b16 v[114:115], v224 offset:11520
    s_waitcnt vmcnt(4) lgkmcnt(14)
    v_mfma_f32_16x16x32_bf16 v[176:179], v[156:159], v[32:35], v[176:179]
    buffer_load_dwordx4 v[0:3], v228, s[4:7], s50 offen sc1
    v_mfma_f32_16x16x32_bf16 v[196:199], v[156:159], v[36:39], v[196:199]
    ds_read_b64_tr_b16 v[116:117], v220 offset:15360
    v_mfma_f32_16x16x32_bf16 v[180:183], v[160:163], v[32:35], v[180:183]
    ds_read_b64_tr_b16 v[118:119], v220 offset:16640
    v_mfma_f32_16x16x32_bf16 v[200:203], v[160:163], v[36:39], v[200:203]
    ds_read_b64_tr_b16 v[120:121], v221 offset:15360
    v_mfma_f32_16x16x32_bf16 v[184:187], v[164:167], v[32:35], v[184:187]
    ds_read_b64_tr_b16 v[122:123], v221 offset:16640
    v_mfma_f32_16x16x32_bf16 v[204:207], v[164:167], v[36:39], v[204:207]
    buffer_load_dwordx4 v[4:7], v228, s[4:7], s51 offen sc1
    v_mfma_f32_16x16x32_bf16 v[188:191], v[168:171], v[32:35], v[188:191]
    ds_read_b64_tr_b16 v[124:125], v222 offset:15360
    v_mfma_f32_16x16x32_bf16 v[208:211], v[168:171], v[36:39], v[208:211]
    ds_read_b64_tr_b16 v[126:127], v222 offset:16640
    v_mfma_f32_16x16x32_bf16 v[192:195], v[172:175], v[32:35], v[192:195]
    ds_read_b64_tr_b16 v[128:129], v223 offset:15360
    v_mfma_f32_16x16x32_bf16 v[212:215], v[172:175], v[36:39], v[212:215]
    ds_read_b64_tr_b16 v[130:131], v223 offset:16640
    ds_read_b64_tr_b16 v[132:133], v224 offset:15360
    s_waitcnt vmcnt(4) lgkmcnt(14)
    v_mfma_f32_16x16x32_bf16 v[176:179], v[56:59], v[40:43], v[176:179]
    s_mov_b32 s50, 30720
    s_mov_b32 s51, 71680
    buffer_load_dwordx4 v[8:11], v216, s[4:7], s50 offen sc1
    v_mfma_f32_16x16x32_bf16 v[196:199], v[56:59], v[44:47], v[196:199]
    ds_read_b64_tr_b16 v[134:135], v224 offset:16640
    v_mfma_f32_16x16x32_bf16 v[180:183], v[60:63], v[40:43], v[180:183]
    ds_read_b64_tr_b16 v[136:137], v220 offset:20480
    v_mfma_f32_16x16x32_bf16 v[200:203], v[60:63], v[44:47], v[200:203]
    ds_read_b64_tr_b16 v[138:139], v220 offset:21760
    v_mfma_f32_16x16x32_bf16 v[184:187], v[64:67], v[40:43], v[184:187]
    ds_read_b64_tr_b16 v[140:141], v221 offset:20480
    v_mfma_f32_16x16x32_bf16 v[204:207], v[64:67], v[44:47], v[204:207]
    buffer_load_dwordx4 v[12:15], v216, s[4:7], s51 offen sc1
    v_mfma_f32_16x16x32_bf16 v[188:191], v[68:71], v[40:43], v[188:191]
    ds_read_b64_tr_b16 v[142:143], v221 offset:21760
    v_mfma_f32_16x16x32_bf16 v[208:211], v[68:71], v[44:47], v[208:211]
    ds_read_b64_tr_b16 v[144:145], v222 offset:20480
    v_mfma_f32_16x16x32_bf16 v[192:195], v[72:75], v[40:43], v[192:195]
    ds_read_b64_tr_b16 v[146:147], v222 offset:21760
    v_mfma_f32_16x16x32_bf16 v[212:215], v[72:75], v[44:47], v[212:215]
    ds_read_b64_tr_b16 v[148:149], v223 offset:20480
    ds_read_b64_tr_b16 v[150:151], v223 offset:21760
    s_waitcnt vmcnt(4) lgkmcnt(14)
    v_mfma_f32_16x16x32_bf16 v[176:179], v[76:79], v[48:51], v[176:179]
    buffer_load_dwordx4 v[16:19], v217, s[4:7], s50 offen sc1
    v_mfma_f32_16x16x32_bf16 v[196:199], v[76:79], v[52:55], v[196:199]
    ds_read_b64_tr_b16 v[152:153], v224 offset:20480
    v_mfma_f32_16x16x32_bf16 v[180:183], v[80:83], v[48:51], v[180:183]
    ds_read_b64_tr_b16 v[154:155], v224 offset:21760
    v_mfma_f32_16x16x32_bf16 v[200:203], v[80:83], v[52:55], v[200:203]
    ds_read_b64_tr_b16 v[156:157], v220 offset:25600
    v_mfma_f32_16x16x32_bf16 v[184:187], v[84:87], v[48:51], v[184:187]
    ds_read_b64_tr_b16 v[158:159], v220 offset:26880
    v_mfma_f32_16x16x32_bf16 v[204:207], v[84:87], v[52:55], v[204:207]
    buffer_load_dwordx4 v[20:23], v217, s[4:7], s51 offen sc1
    v_mfma_f32_16x16x32_bf16 v[188:191], v[88:91], v[48:51], v[188:191]
    ds_read_b64_tr_b16 v[160:161], v221 offset:25600
    v_mfma_f32_16x16x32_bf16 v[208:211], v[88:91], v[52:55], v[208:211]
    ds_read_b64_tr_b16 v[162:163], v221 offset:26880
    v_mfma_f32_16x16x32_bf16 v[192:195], v[92:95], v[48:51], v[192:195]
    ds_read_b64_tr_b16 v[164:165], v222 offset:25600
    v_mfma_f32_16x16x32_bf16 v[212:215], v[92:95], v[52:55], v[212:215]
    ds_read_b64_tr_b16 v[166:167], v222 offset:26880
    ds_read_b64_tr_b16 v[168:169], v223 offset:25600
    s_waitcnt vmcnt(4) lgkmcnt(14)
    v_mfma_f32_16x16x32_bf16 v[176:179], v[96:99], v[0:3], v[176:179]
    buffer_load_dwordx4 v[24:27], v218, s[4:7], s50 offen sc1
    v_mfma_f32_16x16x32_bf16 v[196:199], v[96:99], v[4:7], v[196:199]
    ds_read_b64_tr_b16 v[170:171], v223 offset:26880
    v_mfma_f32_16x16x32_bf16 v[180:183], v[100:103], v[0:3], v[180:183]
    ds_read_b64_tr_b16 v[172:173], v224 offset:25600
    v_mfma_f32_16x16x32_bf16 v[200:203], v[100:103], v[4:7], v[200:203]
    ds_read_b64_tr_b16 v[174:175], v224 offset:26880
    v_mfma_f32_16x16x32_bf16 v[184:187], v[104:107], v[0:3], v[184:187]
    ds_read_b64_tr_b16 v[56:57], v220 offset:30720
    v_mfma_f32_16x16x32_bf16 v[204:207], v[104:107], v[4:7], v[204:207]
    buffer_load_dwordx4 v[28:31], v218, s[4:7], s51 offen sc1
    v_mfma_f32_16x16x32_bf16 v[188:191], v[108:111], v[0:3], v[188:191]
    ds_read_b64_tr_b16 v[58:59], v220 offset:32000
    v_mfma_f32_16x16x32_bf16 v[208:211], v[108:111], v[4:7], v[208:211]
    ds_read_b64_tr_b16 v[60:61], v221 offset:30720
    v_mfma_f32_16x16x32_bf16 v[192:195], v[112:115], v[0:3], v[192:195]
    ds_read_b64_tr_b16 v[62:63], v221 offset:32000
    v_mfma_f32_16x16x32_bf16 v[212:215], v[112:115], v[4:7], v[212:215]
    ds_read_b64_tr_b16 v[64:65], v222 offset:30720
    ds_read_b64_tr_b16 v[66:67], v222 offset:32000
    s_waitcnt vmcnt(4) lgkmcnt(14)
    v_mfma_f32_16x16x32_bf16 v[176:179], v[116:119], v[8:11], v[176:179]
    buffer_load_dwordx4 v[32:35], v219, s[4:7], s50 offen sc1
    v_mfma_f32_16x16x32_bf16 v[196:199], v[116:119], v[12:15], v[196:199]
    ds_read_b64_tr_b16 v[68:69], v223 offset:30720
    v_mfma_f32_16x16x32_bf16 v[180:183], v[120:123], v[8:11], v[180:183]
    ds_read_b64_tr_b16 v[70:71], v223 offset:32000
    v_mfma_f32_16x16x32_bf16 v[200:203], v[120:123], v[12:15], v[200:203]
    ds_read_b64_tr_b16 v[72:73], v224 offset:30720
    v_mfma_f32_16x16x32_bf16 v[184:187], v[124:127], v[8:11], v[184:187]
    ds_read_b64_tr_b16 v[74:75], v224 offset:32000
    v_mfma_f32_16x16x32_bf16 v[204:207], v[124:127], v[12:15], v[204:207]
    buffer_load_dwordx4 v[36:39], v219, s[4:7], s51 offen sc1
    v_mfma_f32_16x16x32_bf16 v[188:191], v[128:131], v[8:11], v[188:191]
    ds_read_b64_tr_b16 v[76:77], v220 offset:35840
    v_mfma_f32_16x16x32_bf16 v[208:211], v[128:131], v[12:15], v[208:211]
    ds_read_b64_tr_b16 v[78:79], v220 offset:37120
    v_mfma_f32_16x16x32_bf16 v[192:195], v[132:135], v[8:11], v[192:195]
    ds_read_b64_tr_b16 v[80:81], v221 offset:35840
    v_mfma_f32_16x16x32_bf16 v[212:215], v[132:135], v[12:15], v[212:215]
    ds_read_b64_tr_b16 v[82:83], v221 offset:37120
    ds_read_b64_tr_b16 v[84:85], v222 offset:35840
    s_waitcnt vmcnt(4) lgkmcnt(14)
    v_mfma_f32_16x16x32_bf16 v[176:179], v[136:139], v[16:19], v[176:179]
    buffer_load_dwordx4 v[40:43], v228, s[4:7], s50 offen sc1
    v_mfma_f32_16x16x32_bf16 v[196:199], v[136:139], v[20:23], v[196:199]
    ds_read_b64_tr_b16 v[86:87], v222 offset:37120
    v_mfma_f32_16x16x32_bf16 v[180:183], v[140:143], v[16:19], v[180:183]
    ds_read_b64_tr_b16 v[88:89], v223 offset:35840
    v_mfma_f32_16x16x32_bf16 v[200:203], v[140:143], v[20:23], v[200:203]
    ds_read_b64_tr_b16 v[90:91], v223 offset:37120
    v_mfma_f32_16x16x32_bf16 v[184:187], v[144:147], v[16:19], v[184:187]
    ds_read_b64_tr_b16 v[92:93], v224 offset:35840
    v_mfma_f32_16x16x32_bf16 v[204:207], v[144:147], v[20:23], v[204:207]
    buffer_load_dwordx4 v[44:47], v228, s[4:7], s51 offen sc1
    v_mfma_f32_16x16x32_bf16 v[188:191], v[148:151], v[16:19], v[188:191]
    ds_read_b64_tr_b16 v[94:95], v224 offset:37120
    v_mfma_f32_16x16x32_bf16 v[208:211], v[148:151], v[20:23], v[208:211]
    v_mfma_f32_16x16x32_bf16 v[192:195], v[152:155], v[16:19], v[192:195]
    v_mfma_f32_16x16x32_bf16 v[212:215], v[152:155], v[20:23], v[212:215]
    s_waitcnt vmcnt(4) lgkmcnt(14)
    v_mfma_f32_16x16x32_bf16 v[176:179], v[156:159], v[24:27], v[176:179]
    v_mfma_f32_16x16x32_bf16 v[196:199], v[156:159], v[28:31], v[196:199]
    v_mfma_f32_16x16x32_bf16 v[180:183], v[160:163], v[24:27], v[180:183]
    v_mfma_f32_16x16x32_bf16 v[200:203], v[160:163], v[28:31], v[200:203]
    v_mfma_f32_16x16x32_bf16 v[184:187], v[164:167], v[24:27], v[184:187]
    v_mfma_f32_16x16x32_bf16 v[204:207], v[164:167], v[28:31], v[204:207]
    v_mfma_f32_16x16x32_bf16 v[188:191], v[168:171], v[24:27], v[188:191]
    v_mfma_f32_16x16x32_bf16 v[208:211], v[168:171], v[28:31], v[208:211]
    v_mfma_f32_16x16x32_bf16 v[192:195], v[172:175], v[24:27], v[192:195]
    v_mfma_f32_16x16x32_bf16 v[212:215], v[172:175], v[28:31], v[212:215]
    s_waitcnt vmcnt(0) lgkmcnt(10)
    s_lshl2_add_u32 s50, s46, s56
    s_mov_b64 exec, 1
    buffer_store_dword v252, v251, s[36:39], s50 offen
    s_mov_b64 exec, -1
    v_mfma_f32_16x16x32_bf16 v[176:179], v[56:59], v[32:35], v[176:179]
    v_mfma_f32_16x16x32_bf16 v[180:183], v[60:63], v[32:35], v[180:183]
    v_mfma_f32_16x16x32_bf16 v[184:187], v[64:67], v[32:35], v[184:187]
    v_mfma_f32_16x16x32_bf16 v[188:191], v[68:71], v[32:35], v[188:191]
    v_mfma_f32_16x16x32_bf16 v[192:195], v[72:75], v[32:35], v[192:195]
    s_waitcnt vmcnt(63) lgkmcnt(0)
    v_mfma_f32_16x16x32_bf16 v[176:179], v[76:79], v[40:43], v[176:179]
    v_mfma_f32_16x16x32_bf16 v[180:183], v[80:83], v[40:43], v[180:183]
    v_mfma_f32_16x16x32_bf16 v[184:187], v[84:87], v[40:43], v[184:187]
    v_mfma_f32_16x16x32_bf16 v[188:191], v[88:91], v[40:43], v[188:191]
    v_mfma_f32_16x16x32_bf16 v[192:195], v[92:95], v[40:43], v[192:195]
    v_and_b32 v227, 28, v251
    buffer_load_dword v247, v227, s[36:39], s56 offen sc1
    v_mfma_f32_16x16x32_bf16 v[196:199], v[56:59], v[36:39], v[196:199]
    v_mfma_f32_16x16x32_bf16 v[200:203], v[60:63], v[36:39], v[200:203]
    v_mfma_f32_16x16x32_bf16 v[204:207], v[64:67], v[36:39], v[204:207]
    v_mfma_f32_16x16x32_bf16 v[208:211], v[68:71], v[36:39], v[208:211]
    v_cvt_pk_bf16_f32 v176, v176, v177
    v_cvt_pk_bf16_f32 v177, v178, v179
    v_mfma_f32_16x16x32_bf16 v[212:215], v[72:75], v[36:39], v[212:215]
    ds_write_b64 v231, v[176:177] offset:0
    v_cvt_pk_bf16_f32 v180, v180, v181
    v_mfma_f32_16x16x32_bf16 v[196:199], v[76:79], v[44:47], v[196:199]
    v_cvt_pk_bf16_f32 v181, v182, v183
    ds_write_b64 v231, v[180:181] offset:8
    v_mfma_f32_16x16x32_bf16 v[200:203], v[80:83], v[44:47], v[200:203]
    v_cvt_pk_bf16_f32 v184, v184, v185
    v_cvt_pk_bf16_f32 v185, v186, v187
    v_mfma_f32_16x16x32_bf16 v[204:207], v[84:87], v[44:47], v[204:207]
    ds_write_b64 v231, v[184:185] offset:16
    v_cvt_pk_bf16_f32 v188, v188, v189
    v_mfma_f32_16x16x32_bf16 v[208:211], v[88:91], v[44:47], v[208:211]
    v_cvt_pk_bf16_f32 v189, v190, v191
    ds_write_b64 v231, v[188:189] offset:24
    v_mfma_f32_16x16x32_bf16 v[212:215], v[92:95], v[44:47], v[212:215]
    v_cvt_pk_bf16_f32 v192, v192, v193
    v_cvt_pk_bf16_f32 v193, v194, v195
    ds_write_b64 v231, v[192:193] offset:32
    s_nop 3
    v_cvt_pk_bf16_f32 v196, v196, v197
    v_cvt_pk_bf16_f32 v197, v198, v199
    ds_write_b64 v231, v[196:197] offset:2816
    v_cvt_pk_bf16_f32 v200, v200, v201
    v_cvt_pk_bf16_f32 v201, v202, v203
    ds_write_b64 v231, v[200:201] offset:2824
    v_cvt_pk_bf16_f32 v204, v204, v205
    v_cvt_pk_bf16_f32 v205, v206, v207
    ds_write_b64 v231, v[204:205] offset:2832
    v_cvt_pk_bf16_f32 v208, v208, v209
    v_cvt_pk_bf16_f32 v209, v210, v211
    ds_write_b64 v231, v[208:209] offset:2840
    v_cvt_pk_bf16_f32 v212, v212, v213
    v_cvt_pk_bf16_f32 v213, v214, v215
    ds_write_b64 v231, v[212:213] offset:2848
    s_waitcnt lgkmcnt(0)
    ds_read_b128 v[0:3], v229
    ds_read_b128 v[4:7], v230
    ds_read_b128 v[8:11], v237
    ds_read_b128 v[12:15], v238
    ds_read_b128 v[16:19], v239
    s_cmp_eq_u32 s34, 0
    s_cbranch_scc1 L_go_51
    s_waitcnt vmcnt(0)
    v_cmp_ne_u32 vcc, s48, v247
    s_cbranch_vccz L_go_51
    s_mov_b32 s52, 100000
L_poll_52:
    buffer_load_dword v247, v227, s[36:39], s56 offen sc1
    s_waitcnt vmcnt(0)
    v_cmp_ne_u32 vcc, s48, v247
    s_cbranch_vccz L_polld_53
    s_sub_u32 s52, s52, 1
    s_cbranch_scc1 L_polld_53
    s_sleep 2
    s_branch L_poll_52
L_polld_53:
L_go_51:
    s_waitcnt lgkmcnt(4)
    buffer_store_dwordx4 v[0:3], v232, s[12:15], 0 offen
    s_waitcnt lgkmcnt(3)
    buffer_store_dwordx4 v[4:7], v233, s[12:15], 0 offen
    s_waitcnt lgkmcnt(2)
    buffer_store_dwordx4 v[8:11], v234, s[12:15], 0 offen
    s_waitcnt lgkmcnt(1)
    buffer_store_dwordx4 v[12:15], v235, s[12:15], 0 offen
    s_waitcnt lgkmcnt(0)
    buffer_store_dwordx4 v[16:19], v236, s[12:15], 0 offen
    s_or_b32 s50, s45, s46
    s_or_b32 s50, s50, s47
    s_cbranch_scc1 L_fin_47
    s_lshl_b32 s51, s44, 7
    s_add_u32 s51, s51, 1572864
    s_mov_b32 exec_hi, 0
    buffer_store_dword v252, v251, s[36:39], s51 offen sc1
    s_mov_b64 exec, -1
L_fin_47:
L_end_1:
    s_endpgm
L_cons_2:
    s_and_b32 s54, s47, 1
    s_lshr_b32 s55, s47, 1
    s_lshl_b32 s51, s54, 13
    v_and_b32 v247, 15, v255
    v_lshrrev_b32 v248, 1, v247
    v_lshrrev_b32 v249, 4, v255
    v_xor_b32 v248, v248, v249
    v_lshl_add_u32 v247, v247, 7, s51
    v_lshl_add_u32 v152, v248, 4, v247
    v_xor_b32 v153, 64, v152
    v_mov_b64 v[0:1], 0
    v_mov_b64 v[2:3], 0
    v_mov_b64 v[4:5], 0
    v_mov_b64 v[6:7], 0
    v_mov_b64 v[8:9], 0
    v_mov_b64 v[10:11], 0
    v_mov_b64 v[12:13], 0
    v_mov_b64 v[14:15], 0
    v_mov_b64 v[16:17], 0
    v_mov_b64 v[18:19], 0
    v_mov_b64 v[20:21], 0
    v_mov_b64 v[22:23], 0
    v_mov_b64 v[24:25], 0
    v_mov_b64 v[26:27], 0
    v_mov_b64 v[28:29], 0
    v_mov_b64 v[30:31], 0
    v_mov_b64 v[32:33], 0
    v_mov_b64 v[34:35], 0
    v_mov_b64 v[36:37], 0
    v_mov_b64 v[38:39], 0
    v_mov_b64 v[40:41], 0
    v_mov_b64 v[42:43], 0
    v_mov_b64 v[44:45], 0
    v_mov_b64 v[46:47], 0
    v_mov_b64 v[48:49], 0
    v_mov_b64 v[50:51], 0
    v_mov_b64 v[52:53], 0
    v_mov_b64 v[54:55], 0
    v_mov_b64 v[56:57], 0
    v_mov_b64 v[58:59], 0
    v_mov_b64 v[60:61], 0
    v_mov_b64 v[62:63], 0
    v_mov_b64 v[64:65], 0
    v_mov_b64 v[66:67], 0
    v_mov_b64 v[68:69], 0
    v_mov_b64 v[70:71], 0
    v_mov_b64 v[72:73], 0
    v_mov_b64 v[74:75], 0
    v_mov_b64 v[76:77], 0
    v_mov_b64 v[78:79], 0
    s_waitcnt lgkmcnt(0)
    s_cmp_eq_u32 s44, 0
    s_cselect_b64 s[16:17], s[16:17], s[22:23]
    s_cselect_b64 s[18:19], s[18:19], s[24:25]
    s_cselect_b64 s[20:21], s[20:21], s[26:27]
    s_lshl_b32 s50, s44, 7
    s_add_u32 s50, s50, 18350080
    s_load_dword s48, s[32:33], s50
    s_add_u32 s36, s32, 16777216
    s_addc_u32 s37, s33, 0
    s_mov_b32 s38, 1576960
    s_mov_b32 s39, 0x00020000
    s_lshl3_add_u32 s50, s44, s46
    s_lshl2_add_u32 s50, s50, s61
    s_mul_i32 s50, s50, 163840
    s_add_u32 s12, s32, s50
    s_addc_u32 s13, s33, 0
    s_mov_b32 s14, 163840
    s_mov_b32 s15, 0x00020000
    v_lshlrev_b32 v240, 4, v255
    v_lshlrev_b32 v241, 3, v255
    v_and_b32 v247, 31, v255
    v_lshrrev_b32 v248, 1, v247
    v_xor_b32 v248, v248, v247
    v_and_b32 v248, 4, v248
    v_mul_u32_u24 v248, 3, v248
    v_xor_b32 v248, v248, v247
    s_and_b32 s50, s61, 1
    s_lshl_b32 s50, s50, 2
    v_add_u32 v248, s50, v248
    v_subrev_u32 v249, 20, v248
    v_min_u32 v248, v248, v249
    v_lshrrev_b32 v249, 5, v255
    v_mul_u32_u24 v250, 320, v249
    v_lshl_add_u32 v242, v248, 4, v250
    v_add_u32 v242, 2560, v242
    s_and_b32 s59, s45, 12
    s_lshl1_add_u32 s59, s59, s58
    s_mul_i32 s59, s59, 5120
    s_mov_b32 s62, 0x000fffff
    s_mov_b32 s63, 0x000fffff
    s_lshl_b32 s35, s44, 9
    s_add_u32 s35, s35, 491520
    v_and_b32 v244, 3, v255
    v_lshlrev_b32 v244, 7, v244
    s_min_u32 s50, s47, 4
    s_lshl_b32 s51, s50, 6
    v_add_u32 v247, s51, v255
    v_mul_u32_u24 v248, 3277, v247
    v_lshrrev_b32 v248, 16, v248
    v_mad_i32_i24 v249, v248, -16, v247
    v_mad_i32_i24 v249, v248, -4, v249
    v_lshrrev_b32 v252, 3, v248
    v_mad_i32_i24 v249, v252, -2, v249
    v_add_u32 v252, 20, v249
    v_min_u32 v249, v249, v252
    s_movk_i32 s52, 1280
    v_cmp_lt_u32 vcc, 9, v249
    v_add_u32 v252, 16, v248
    v_subrev_u32 v251, 10, v249
    v_cndmask_b32 v248, v248, v252, vcc
    v_cndmask_b32 v249, v249, v251, vcc
    v_lshlrev_b32 v249, 4, v249
    v_mad_u32_u24 v243, v248, s52, v249
    s_and_b32 s50, s46, 3
    s_lshl2_add_u32 s50, s44, s50
    s_lshl1_add_u32 s50, s50, s55
    s_mul_i32 s50, s50, 655360
    s_lshl1_add_u32 s51, s45, s54
    s_mul_i32 s51, s51, 5120
    s_add_u32 s50, s50, s51
    s_add_u32 s40, s32, s50
    s_addc_u32 s41, s33, 0
    s_mov_b32 s42, 496640
    s_mov_b32 s43, 0x00020000
    s_lshl3_add_u32 s50, s44, s46
    s_lshl1_add_u32 s50, s50, s55
    s_lshl4_add_u32 s50, s50, s45
    s_lshl1_add_u32 s60, s50, s54
    s_lshr_b32 s49, s60, 3
    s_lshl_b32 s49, s49, 7
    s_and_b32 s50, s60, 7
    s_lshl2_add_u32 s49, s50, s49
    s_add_u32 s49, s49, 262144
    s_and_b32 s60, s2, 7
    s_lshl_b32 s60, s60, 7
    s_add_u32 s60, s60, 491520
    s_waitcnt lgkmcnt(0)
    s_mul_i32 s48, s48, 0x9E3779B1
    s_add_u32 s48, s48, 0x7F4A7C15
    s_getreg_b32 s34, hwreg(HW_REG_XCC_ID)
    s_and_b32 s34, s34, 7
    s_add_u32 s34, s34, s48
    s_and_b32 s50, s2, 7
    s_lshl_b32 s57, s50, 12
    s_add_u32 s57, s57, 458752
    s_lshr_b32 s50, s2, 3
    s_lshl_b32 s50, s50, 7
    s_add_u32 s24, s50, s57
    s_cmp_eq_u32 s47, 0
    s_cselect_b32 s25, 1, 99
    v_and_b32 v160, 31, v255
    v_lshlrev_b32 v160, 7, v160
    s_lshl4_add_u32 s3, s44, s46
    s_lshr_b32 s50, s45, 2
    s_lshl2_add_u32 s3, s3, s50
    s_lshl_b32 s3, s3, 7
    s_add_u32 s3, s3, 262144
    v_and_b32 v247, 7, v255
    v_lshrrev_b32 v248, 5, v255
    v_lshlrev_b32 v247, 2, v247
    v_lshl_add_u32 v246, v248, 12, v247
    v_bfe_u32 v247, v255, 2, 2
    v_lshrrev_b32 v248, 4, v255
    v_and_b32 v249, 1, v248
    v_lshl_add_u32 v247, v249, 3, v247
    v_mul_u32_u24 v247, 320, v247
    v_add_u32 v247, 61440, v247
    v_lshlrev_b32 v249, 5, v249
    v_lshrrev_b32 v248, 1, v248
    v_mul_u32_u24 v248, 160, v248
    v_add_u32 v249, v249, v248
    v_and_b32 v248, 3, v255
    v_mad_u32_u24 v249, v248, 40, v249
    v_add_u32 v248, 0, v249
    v_subrev_u32 v250, 320, v248
    v_min_u32 v248, v248, v250
    v_add_u32 v220, v248, v247
    v_add_u32 v248, 8, v249
    v_subrev_u32 v250, 320, v248
    v_min_u32 v248, v248, v250
    v_add_u32 v221, v248, v247
    v_add_u32 v248, 16, v249
    v_subrev_u32 v250, 320, v248
    v_min_u32 v248, v248, v250
    v_add_u32 v222, v248, v247
    v_add_u32 v248, 24, v249
    v_subrev_u32 v250, 320, v248
    v_min_u32 v248, v248, v250
    v_add_u32 v223, v248, v247
    v_add_u32 v248, 32, v249
    v_subrev_u32 v250, 320, v248
    v_min_u32 v248, v248, v250
    v_add_u32 v224, v248, v247
    v_and_b32 v247, 15, v255
    v_lshrrev_b32 v248, 4, v255
    s_movk_i32 s50, 1280
    v_add_u32 v249, 0, v248
    v_mul_u32_u24 v250, 205, v249
    v_lshrrev_b32 v250, 10, v250
    v_lshlrev_b32 v249, 8, v249
    v_mad_u32_u24 v249, v250, s50, v249
    v_lshl_add_u32 v216, v247, 4, v249
    v_add_u32 v249, 4, v248
    v_mul_u32_u24 v250, 205, v249
    v_lshrrev_b32 v250, 10, v250
    v_lshlrev_b32 v249, 8, v249
    v_mad_u32_u24 v249, v250, s50, v249
    v_lshl_add_u32 v217, v247, 4, v249
    v_add_u32 v249, 8, v248
    v_mul_u32_u24 v250, 205, v249
    v_lshrrev_b32 v250, 10, v250
    v_lshlrev_b32 v249, 8, v249
    v_mad_u32_u24 v249, v250, s50, v249
    v_lshl_add_u32 v218, v247, 4, v249
    v_add_u32 v249, 12, v248
    v_mul_u32_u24 v250, 205, v249
    v_lshrrev_b32 v250, 10, v250
    v_lshlrev_b32 v249, 8, v249
    v_mad_u32_u24 v249, v250, s50, v249
    v_lshl_add_u32 v219, v247, 4, v249
    v_add_u32 v249, 16, v248
    v_mul_u32_u24 v250, 205, v249
    v_lshrrev_b32 v250, 10, v250
    v_lshlrev_b32 v249, 8, v249
    v_mad_u32_u24 v249, v250, s50, v249
    v_lshl_add_u32 v228, v247, 4, v249
    s_xor_b32 s51, s47, 4
    s_mul_i32 s51, s51, 6144
    v_mul_u32_u24 v247, 176, v247
    v_mad_u32_u24 v247, v248, 40, v247
    v_add_u32 v231, s51, v247
    s_movk_i32 s50, 2400
    v_add_u32 v247, 0, v255
    v_mul_u32_u24 v248, 6554, v247
    v_lshrrev_b32 v248, 16, v248
    v_lshlrev_b32 v247, 4, v247
    v_mad_u32_u24 v232, v248, s50, v247
    v_lshl_add_u32 v247, v248, 4, v247
    v_add_u32 v229, s51, v247
    v_add_u32 v247, 64, v255
    v_mul_u32_u24 v248, 6554, v247
    v_lshrrev_b32 v248, 16, v248
    v_lshlrev_b32 v247, 4, v247
    v_mad_u32_u24 v233, v248, s50, v247
    v_lshl_add_u32 v247, v248, 4, v247
    v_add_u32 v230, s51, v247
    v_add_u32 v247, 128, v255
    v_mul_u32_u24 v248, 6554, v247
    v_lshrrev_b32 v248, 16, v248
    v_lshlrev_b32 v247, 4, v247
    v_mad_u32_u24 v234, v248, s50, v247
    v_lshl_add_u32 v247, v248, 4, v247
    v_add_u32 v237, s51, v247
    v_add_u32 v247, 192, v255
    v_mul_u32_u24 v248, 6554, v247
    v_lshrrev_b32 v248, 16, v248
    v_lshlrev_b32 v247, 4, v247
    v_mad_u32_u24 v235, v248, s50, v247
    v_lshl_add_u32 v247, v248, 4, v247
    v_add_u32 v238, s51, v247
    v_add_u32 v247, 256, v255
    v_mul_u32_u24 v248, 6554, v247
    v_lshrrev_b32 v248, 16, v248
    v_lshlrev_b32 v247, 4, v247
    v_mad_u32_u24 v236, v248, s50, v247
    v_lshl_add_u32 v247, v248, 4, v247
    v_add_u32 v239, s51, v247
    v_mov_b64 v[226:227], 0
    v_mov_b32 v225, 0
    s_mov_b32 s53, 0
    s_mov_b32 s56, 4294856704
    s_cmp_ge_u32 s46, 4
    s_cbranch_scc1 L_vtype_3
    v_bfe_u32 v247, v255, 2, 2
    v_lshrrev_b32 v248, 4, v255
    v_and_b32 v249, 1, v248
    v_lshl_add_u32 v247, v248, 3, v247
    v_mul_u32_u24 v247, 320, v247
    v_add_u32 v247, 16384, v247
    v_lshlrev_b32 v249, 5, v249
    s_mul_i32 s50, s55, 160
    v_add_u32 v249, s50, v249
    v_and_b32 v248, 3, v255
    v_mad_u32_u24 v249, v248, 40, v249
    v_add_u32 v248, 0, v249
    v_subrev_u32 v250, 320, v248
    v_min_u32 v248, v248, v250
    v_add_u32 v154, v248, v247
    v_add_u32 v248, 8, v249
    v_subrev_u32 v250, 320, v248
    v_min_u32 v248, v248, v250
    v_add_u32 v155, v248, v247
    v_add_u32 v248, 16, v249
    v_subrev_u32 v250, 320, v248
    v_min_u32 v248, v248, v250
    v_add_u32 v156, v248, v247
    v_add_u32 v248, 24, v249
    v_subrev_u32 v250, 320, v248
    v_min_u32 v248, v248, v250
    v_add_u32 v157, v248, v247
    v_add_u32 v248, 32, v249
    v_subrev_u32 v250, 320, v248
    v_min_u32 v248, v248, v250
    v_add_u32 v158, v248, v247
    v_lshrrev_b32 v247, 4, v255
    s_mov_b32 s50, 163840
    v_mul_lo_u32 v247, v247, s50
    v_and_b32 v248, 7, v255
    v_and_b32 v249, 8, v255
    v_lshl_add_u32 v248, v249, 1, v248
    v_lshl_add_u32 v163, v248, 4, v247
    v_lshl_add_u32 v164, v248, 3, v247
    s_barrier
    ds_read_b128 v[80:83], v152 offset:0
    ds_read_b128 v[84:87], v152 offset:2048
    ds_read_b128 v[88:91], v152 offset:4096
    ds_read_b128 v[92:95], v152 offset:6144
    ds_read_b64_tr_b16 v[112:113], v154 offset:0
    ds_read_b64_tr_b16 v[114:115], v154 offset:1280
    ds_read_b64_tr_b16 v[116:117], v155 offset:0
    ds_read_b64_tr_b16 v[118:119], v155 offset:1280
    ds_read_b64_tr_b16 v[120:121], v156 offset:0
    ds_read_b64_tr_b16 v[122:123], v156 offset:1280
    ds_read_b64_tr_b16 v[124:125], v157 offset:0
    ds_read_b64_tr_b16 v[126:127], v157 offset:1280
    ds_read_b64_tr_b16 v[128:129], v158 offset:0
    ds_read_b64_tr_b16 v[130:131], v158 offset:1280
L_p1_55:
    s_waitcnt lgkmcnt(8)
    v_mfma_f32_16x16x32_bf16 v[0:3], v[112:115], v[80:83], v[0:3]
    ds_read_b128 v[96:99], v153 offset:0
    v_mfma_f32_16x16x32_bf16 v[20:23], v[112:115], v[84:87], v[20:23]
    ds_read_b128 v[100:103], v153 offset:2048
    v_mfma_f32_16x16x32_bf16 v[40:43], v[112:115], v[88:91], v[40:43]
    ds_read_b128 v[104:107], v153 offset:4096
    v_mfma_f32_16x16x32_bf16 v[60:63], v[112:115], v[92:95], v[60:63]
    ds_read_b128 v[108:111], v153 offset:6144
    s_waitcnt lgkmcnt(4)
    v_mfma_f32_16x16x32_bf16 v[4:7], v[116:119], v[80:83], v[4:7]
    ds_read_b64_tr_b16 v[132:133], v154 offset:10240
    v_mfma_f32_16x16x32_bf16 v[24:27], v[116:119], v[84:87], v[24:27]
    ds_read_b64_tr_b16 v[134:135], v154 offset:11520
    v_mfma_f32_16x16x32_bf16 v[44:47], v[116:119], v[88:91], v[44:47]
    ds_read_b64_tr_b16 v[136:137], v155 offset:10240
    v_mfma_f32_16x16x32_bf16 v[64:67], v[116:119], v[92:95], v[64:67]
    ds_read_b64_tr_b16 v[138:139], v155 offset:11520
    v_mfma_f32_16x16x32_bf16 v[8:11], v[120:123], v[80:83], v[8:11]
    ds_read_b64_tr_b16 v[140:141], v156 offset:10240
    v_mfma_f32_16x16x32_bf16 v[28:31], v[120:123], v[84:87], v[28:31]
    ds_read_b64_tr_b16 v[142:143], v156 offset:11520
    v_mfma_f32_16x16x32_bf16 v[48:51], v[120:123], v[88:91], v[48:51]
    ds_read_b64_tr_b16 v[144:145], v157 offset:10240
    v_mfma_f32_16x16x32_bf16 v[68:71], v[120:123], v[92:95], v[68:71]
    ds_read_b64_tr_b16 v[146:147], v157 offset:11520
    v_mfma_f32_16x16x32_bf16 v[12:15], v[124:127], v[80:83], v[12:15]
    ds_read_b64_tr_b16 v[148:149], v158 offset:10240
    v_mfma_f32_16x16x32_bf16 v[32:35], v[124:127], v[84:87], v[32:35]
    ds_read_b64_tr_b16 v[150:151], v158 offset:11520
    v_mfma_f32_16x16x32_bf16 v[52:55], v[124:127], v[88:91], v[52:55]
    s_add_u32 s53, s53, 1
    v_mfma_f32_16x16x32_bf16 v[72:75], v[124:127], v[92:95], v[72:75]
    s_and_b32 s50, s53, 3
    v_mfma_f32_16x16x32_bf16 v[16:19], v[128:131], v[80:83], v[16:19]
    s_cselect_b32 s50, 36864, s56
    v_mfma_f32_16x16x32_bf16 v[36:39], v[128:131], v[84:87], v[36:39]
    s_cmp_eq_u32 s53, 10
    v_mfma_f32_16x16x32_bf16 v[56:59], v[128:131], v[88:91], v[56:59]
    v_mfma_f32_16x16x32_bf16 v[76:79], v[128:131], v[92:95], v[76:79]
    s_waitcnt lgkmcnt(8)
    v_mfma_f32_16x16x32_bf16 v[0:3], v[132:135], v[96:99], v[0:3]
    v_add_u32 v152, s50, v152
    v_add_u32 v153, s50, v153
    v_mfma_f32_16x16x32_bf16 v[20:23], v[132:135], v[100:103], v[20:23]
    v_add_u32 v154, s50, v154
    v_add_u32 v155, s50, v155
    v_mfma_f32_16x16x32_bf16 v[40:43], v[132:135], v[104:107], v[40:43]
    v_add_u32 v156, s50, v156
    v_add_u32 v157, s50, v157
    v_mfma_f32_16x16x32_bf16 v[60:63], v[132:135], v[108:111], v[60:63]
    v_add_u32 v158, s50, v158
    s_waitcnt lgkmcnt(0)
    s_barrier
    s_cbranch_scc1 L_p1l_56
    v_mfma_f32_16x16x32_bf16 v[4:7], v[136:139], v[96:99], v[4:7]
    ds_read_b128 v[80:83], v152 offset:0
    v_mfma_f32_16x16x32_bf16 v[24:27], v[136:139], v[100:103], v[24:27]
    ds_read_b128 v[84:87], v152 offset:2048
    v_mfma_f32_16x16x32_bf16 v[44:47], v[136:139], v[104:107], v[44:47]
    ds_read_b128 v[88:91], v152 offset:4096
    v_mfma_f32_16x16x32_bf16 v[64:67], v[136:139], v[108:111], v[64:67]
    ds_read_b128 v[92:95], v152 offset:6144
    v_mfma_f32_16x16x32_bf16 v[8:11], v[140:143], v[96:99], v[8:11]
    ds_read_b64_tr_b16 v[112:113], v154 offset:0
    v_mfma_f32_16x16x32_bf16 v[28:31], v[140:143], v[100:103], v[28:31]
    ds_read_b64_tr_b16 v[114:115], v154 offset:1280
    v_mfma_f32_16x16x32_bf16 v[48:51], v[140:143], v[104:107], v[48:51]
    ds_read_b64_tr_b16 v[116:117], v155 offset:0
    v_mfma_f32_16x16x32_bf16 v[68:71], v[140:143], v[108:111], v[68:71]
    ds_read_b64_tr_b16 v[118:119], v155 offset:1280
    v_mfma_f32_16x16x32_bf16 v[12:15], v[144:147], v[96:99], v[12:15]
    ds_read_b64_tr_b16 v[120:121], v156 offset:0
    v_mfma_f32_16x16x32_bf16 v[32:35], v[144:147], v[100:103], v[32:35]
    ds_read_b64_tr_b16 v[122:123], v156 offset:1280
    v_mfma_f32_16x16x32_bf16 v[52:55], v[144:147], v[104:107], v[52:55]
    ds_read_b64_tr_b16 v[124:125], v157 offset:0
    v_mfma_f32_16x16x32_bf16 v[72:75], v[144:147], v[108:111], v[72:75]
    ds_read_b64_tr_b16 v[126:127], v157 offset:1280
    v_mfma_f32_16x16x32_bf16 v[16:19], v[148:151], v[96:99], v[16:19]
    ds_read_b64_tr_b16 v[128:129], v158 offset:0
    v_mfma_f32_16x16x32_bf16 v[36:39], v[148:151], v[100:103], v[36:39]
    ds_read_b64_tr_b16 v[130:131], v158 offset:1280
    v_mfma_f32_16x16x32_bf16 v[56:59], v[148:151], v[104:107], v[56:59]
    v_mfma_f32_16x16x32_bf16 v[76:79], v[148:151], v[108:111], v[76:79]
    s_cmp_lg_u32 s53, s25
    s_cbranch_scc1 L_p1q_57
    v_lshlrev_b32 v251, 2, v255
    v_mov_b32 v252, s34
    s_mov_b32 exec_hi, 0
    buffer_store_dword v252, v251, s[36:39], s24 offen sc1
    s_mov_b64 exec, -1
L_p1q_57:
    s_cmp_lg_u32 s53, 8
    s_cbranch_scc1 L_p1_55
    buffer_load_dword v159, v246, s[36:39], s3 offen sc1
    buffer_load_dword v159, v160, s[36:39], s57 offen sc1
    s_branch L_p1_55
L_p1l_56:
    v_mfma_f32_16x16x32_bf16 v[4:7], v[136:139], v[96:99], v[4:7]
    v_mfma_f32_16x16x32_bf16 v[24:27], v[136:139], v[100:103], v[24:27]
    v_mfma_f32_16x16x32_bf16 v[44:47], v[136:139], v[104:107], v[44:47]
    v_mfma_f32_16x16x32_bf16 v[64:67], v[136:139], v[108:111], v[64:67]
    v_mfma_f32_16x16x32_bf16 v[8:11], v[140:143], v[96:99], v[8:11]
    v_mfma_f32_16x16x32_bf16 v[28:31], v[140:143], v[100:103], v[28:31]
    v_mfma_f32_16x16x32_bf16 v[48:51], v[140:143], v[104:107], v[48:51]
    v_mfma_f32_16x16x32_bf16 v[68:71], v[140:143], v[108:111], v[68:71]
    v_mfma_f32_16x16x32_bf16 v[12:15], v[144:147], v[96:99], v[12:15]
    v_mfma_f32_16x16x32_bf16 v[32:35], v[144:147], v[100:103], v[32:35]
    v_mfma_f32_16x16x32_bf16 v[52:55], v[144:147], v[104:107], v[52:55]
    v_mfma_f32_16x16x32_bf16 v[72:75], v[144:147], v[108:111], v[72:75]
    v_mfma_f32_16x16x32_bf16 v[16:19], v[148:151], v[96:99], v[16:19]
    v_mfma_f32_16x16x32_bf16 v[36:39], v[148:151], v[100:103], v[36:39]
    v_mfma_f32_16x16x32_bf16 v[56:59], v[148:151], v[104:107], v[56:59]
    v_mfma_f32_16x16x32_bf16 v[76:79], v[148:151], v[108:111], v[76:79]
    s_mov_b32 s52, 100000
L_xt_58:
    s_waitcnt vmcnt(0)
    v_subrev_u32 v247, s48, v159
    v_cmp_lt_u32 vcc, 7, v247
    s_cbranch_vccz L_xtd_59
    s_sub_u32 s52, s52, 1
    s_cbranch_scc1 L_xtd_59
    s_sleep 2
    buffer_load_dword v159, v160, s[36:39], s57 offen sc1
    s_branch L_xt_58
L_xtd_59:
    v_cmp_ne_u32 vcc, s34, v159
    s_cmp_eq_u64 vcc, 0
    s_cselect_b32 s34, 1, 0
    s_cmp_eq_u32 s34, 0
    s_cbranch_scc1 L_glob_60
    v_cvt_pk_bf16_f32 v80, v0, v1
    v_cvt_pk_bf16_f32 v81, v2, v3
    v_cvt_pk_bf16_f32 v82, v4, v5
    v_cvt_pk_bf16_f32 v83, v6, v7
    v_cvt_pk_bf16_f32 v84, v8, v9
    v_cvt_pk_bf16_f32 v85, v10, v11
    v_cvt_pk_bf16_f32 v86, v12, v13
    v_cvt_pk_bf16_f32 v87, v14, v15
    v_cvt_pk_bf16_f32 v88, v16, v17
    v_cvt_pk_bf16_f32 v89, v18, v19
    buffer_store_dwordx4 v[80:83], v163, s[40:43], 0 offen offset:0
    buffer_store_dwordx4 v[84:87], v163, s[40:43], 0 offen offset:512
    buffer_store_dwordx2 v[88:89], v164, s[40:43], 0 offen offset:2048
    v_cvt_pk_bf16_f32 v90, v20, v21
    v_cvt_pk_bf16_f32 v91, v22, v23
    v_cvt_pk_bf16_f32 v92, v24, v25
    v_cvt_pk_bf16_f32 v93, v26, v27
    v_cvt_pk_bf16_f32 v94, v28, v29
    v_cvt_pk_bf16_f32 v95, v30, v31
    v_cvt_pk_bf16_f32 v96, v32, v33
    v_cvt_pk_bf16_f32 v97, v34, v35
    v_cvt_pk_bf16_f32 v98, v36, v37
    v_cvt_pk_bf16_f32 v99, v38, v39
    buffer_store_dwordx4 v[90:93], v163, s[40:43], 0 offen offset:128
    buffer_store_dwordx4 v[94:97], v163, s[40:43], 0 offen offset:640
    buffer_store_dwordx2 v[98:99], v164, s[40:43], 0 offen offset:2112
    v_cvt_pk_bf16_f32 v100, v40, v41
    v_cvt_pk_bf16_f32 v101, v42, v43
    v_cvt_pk_bf16_f32 v102, v44, v45
    v_cvt_pk_bf16_f32 v103, v46, v47
    v_cvt_pk_bf16_f32 v104, v48, v49
    v_cvt_pk_bf16_f32 v105, v50, v51
    v_cvt_pk_bf16_f32 v106, v52, v53
    v_cvt_pk_bf16_f32 v107, v54, v55
    v_cvt_pk_bf16_f32 v108, v56, v57
    v_cvt_pk_bf16_f32 v109, v58, v59
    buffer_store_dwordx4 v[100:103], v163, s[40:43], 0 offen offset:1024
    buffer_store_dwordx4 v[104:107], v163, s[40:43], 0 offen offset:1536
    buffer_store_dwordx2 v[108:109], v164, s[40:43], 0 offen offset:2304
    v_cvt_pk_bf16_f32 v110, v60, v61
    v_cvt_pk_bf16_f32 v111, v62, v63
    v_cvt_pk_bf16_f32 v112, v64, v65
    v_cvt_pk_bf16_f32 v113, v66, v67
    v_cvt_pk_bf16_f32 v114, v68, v69
    v_cvt_pk_bf16_f32 v115, v70, v71
    v_cvt_pk_bf16_f32 v116, v72, v73
    v_cvt_pk_bf16_f32 v117, v74, v75
    v_cvt_pk_bf16_f32 v118, v76, v77
    v_cvt_pk_bf16_f32 v119, v78, v79
    buffer_store_dwordx4 v[110:113], v163, s[40:43], 0 offen offset:1152
    buffer_store_dwordx4 v[114:117], v163, s[40:43], 0 offen offset:1664
    buffer_store_dwordx2 v[118:119], v164, s[40:43], 0 offen offset:2368
    s_branch L_cj_54
L_glob_60:
    v_cvt_pk_bf16_f32 v80, v0, v1
    v_cvt_pk_bf16_f32 v81, v2, v3
    v_cvt_pk_bf16_f32 v82, v4, v5
    v_cvt_pk_bf16_f32 v83, v6, v7
    v_cvt_pk_bf16_f32 v84, v8, v9
    v_cvt_pk_bf16_f32 v85, v10, v11
    v_cvt_pk_bf16_f32 v86, v12, v13
    v_cvt_pk_bf16_f32 v87, v14, v15
    v_cvt_pk_bf16_f32 v88, v16, v17
    v_cvt_pk_bf16_f32 v89, v18, v19
    buffer_store_dwordx4 v[80:83], v163, s[40:43], 0 offen offset:0 sc1
    buffer_store_dwordx4 v[84:87], v163, s[40:43], 0 offen offset:512 sc1
    buffer_store_dwordx2 v[88:89], v164, s[40:43], 0 offen offset:2048 sc1
    v_cvt_pk_bf16_f32 v90, v20, v21
    v_cvt_pk_bf16_f32 v91, v22, v23
    v_cvt_pk_bf16_f32 v92, v24, v25
    v_cvt_pk_bf16_f32 v93, v26, v27
    v_cvt_pk_bf16_f32 v94, v28, v29
    v_cvt_pk_bf16_f32 v95, v30, v31
    v_cvt_pk_bf16_f32 v96, v32, v33
    v_cvt_pk_bf16_f32 v97, v34, v35
    v_cvt_pk_bf16_f32 v98, v36, v37
    v_cvt_pk_bf16_f32 v99, v38, v39
    buffer_store_dwordx4 v[90:93], v163, s[40:43], 0 offen offset:128 sc1
    buffer_store_dwordx4 v[94:97], v163, s[40:43], 0 offen offset:640 sc1
    buffer_store_dwordx2 v[98:99], v164, s[40:43], 0 offen offset:2112 sc1
    v_cvt_pk_bf16_f32 v100, v40, v41
    v_cvt_pk_bf16_f32 v101, v42, v43
    v_cvt_pk_bf16_f32 v102, v44, v45
    v_cvt_pk_bf16_f32 v103, v46, v47
    v_cvt_pk_bf16_f32 v104, v48, v49
    v_cvt_pk_bf16_f32 v105, v50, v51
    v_cvt_pk_bf16_f32 v106, v52, v53
    v_cvt_pk_bf16_f32 v107, v54, v55
    v_cvt_pk_bf16_f32 v108, v56, v57
    v_cvt_pk_bf16_f32 v109, v58, v59
    buffer_store_dwordx4 v[100:103], v163, s[40:43], 0 offen offset:1024 sc1
    buffer_store_dwordx4 v[104:107], v163, s[40:43], 0 offen offset:1536 sc1
    buffer_store_dwordx2 v[108:109], v164, s[40:43], 0 offen offset:2304 sc1
    v_cvt_pk_bf16_f32 v110, v60, v61
    v_cvt_pk_bf16_f32 v111, v62, v63
    v_cvt_pk_bf16_f32 v112, v64, v65
    v_cvt_pk_bf16_f32 v113, v66, v67
    v_cvt_pk_bf16_f32 v114, v68, v69
    v_cvt_pk_bf16_f32 v115, v70, v71
    v_cvt_pk_bf16_f32 v116, v72, v73
    v_cvt_pk_bf16_f32 v117, v74, v75
    v_cvt_pk_bf16_f32 v118, v76, v77
    v_cvt_pk_bf16_f32 v119, v78, v79
    buffer_store_dwordx4 v[110:113], v163, s[40:43], 0 offen offset:1152 sc1
    buffer_store_dwordx4 v[114:117], v163, s[40:43], 0 offen offset:1664 sc1
    buffer_store_dwordx2 v[118:119], v164, s[40:43], 0 offen offset:2368 sc1
    s_branch L_cj_54
L_vtype_3:
    v_bfe_u32 v247, v255, 2, 2
    v_lshrrev_b32 v248, 4, v255
    v_and_b32 v249, 1, v248
    v_lshl_add_u32 v247, v248, 3, v247
    v_mul_u32_u24 v247, 320, v247
    v_add_u32 v247, 16384, v247
    v_lshlrev_b32 v249, 5, v249
    s_mul_i32 s50, s55, 160
    v_add_u32 v249, s50, v249
    v_and_b32 v248, 3, v255
    v_mad_u32_u24 v249, v248, 8, v249
    v_add_u32 v248, 0, v249
    v_subrev_u32 v250, 320, v248
    v_min_u32 v248, v248, v250
    v_add_u32 v154, v248, v247
    v_add_u32 v248, 32, v249
    v_subrev_u32 v250, 320, v248
    v_min_u32 v248, v248, v250
    v_add_u32 v155, v248, v247
    v_add_u32 v248, 64, v249
    v_subrev_u32 v250, 320, v248
    v_min_u32 v248, v248, v250
    v_add_u32 v156, v248, v247
    v_add_u32 v248, 96, v249
    v_subrev_u32 v250, 320, v248
    v_min_u32 v248, v248, v250
    v_add_u32 v157, v248, v247
    v_add_u32 v248, 128, v249
    v_subrev_u32 v250, 320, v248
    v_min_u32 v248, v248, v250
    v_add_u32 v158, v248, v247
    v_lshrrev_b32 v247, 4, v255
    v_mul_u32_u24 v247, 320, v247
    v_and_b32 v248, 15, v255
    s_mov_b32 s50, 163520
    v_add_u32 v249, 0, v248
    v_mul_u32_u24 v250, 3277, v249
    v_lshrrev_b32 v250, 16, v250
    v_lshl_add_u32 v249, v249, 4, v247
    v_mad_u32_u24 v163, v250, s50, v249
    v_add_u32 v249, 16, v248
    v_mul_u32_u24 v250, 3277, v249
    v_lshrrev_b32 v250, 16, v250
    v_lshl_add_u32 v249, v249, 4, v247
    v_mad_u32_u24 v164, v250, s50, v249
    v_add_u32 v249, 32, v248
    v_mul_u32_u24 v250, 3277, v249
    v_lshrrev_b32 v250, 16, v250
    v_lshl_add_u32 v249, v249, 4, v247
    v_mad_u32_u24 v165, v250, s50, v249
    v_add_u32 v249, 48, v248
    v_mul_u32_u24 v250, 3277, v249
    v_lshrrev_b32 v250, 16, v250
    v_lshl_add_u32 v249, v249, 4, v247
    v_mad_u32_u24 v166, v250, s50, v249
    v_add_u32 v249, 64, v248
    v_mul_u32_u24 v250, 3277, v249
    v_lshrrev_b32 v250, 16, v250
    v_lshl_add_u32 v249, v249, 4, v247
    v_mad_u32_u24 v167, v250, s50, v249
    s_barrier
    ds_read_b128 v[80:83], v152 offset:0
    ds_read_b128 v[84:87], v152 offset:2048
    ds_read_b128 v[88:91], v152 offset:4096
    ds_read_b128 v[92:95], v152 offset:6144
    ds_read_b64_tr_b16 v[112:113], v154 offset:0
    ds_read_b64_tr_b16 v[114:115], v154 offset:1280
    ds_read_b64_tr_b16 v[116:117], v155 offset:0
    ds_read_b64_tr_b16 v[118:119], v155 offset:1280
    ds_read_b64_tr_b16 v[120:121], v156 offset:0
    ds_read_b64_tr_b16 v[122:123], v156 offset:1280
    ds_read_b64_tr_b16 v[124:125], v157 offset:0
    ds_read_b64_tr_b16 v[126:127], v157 offset:1280
    ds_read_b64_tr_b16 v[128:129], v158 offset:0
    ds_read_b64_tr_b16 v[130:131], v158 offset:1280
L_p1_61:
    s_waitcnt lgkmcnt(8)
    v_mfma_f32_16x16x32_bf16 v[0:3], v[80:83], v[112:115], v[0:3]
    ds_read_b128 v[96:99], v153 offset:0
    v_mfma_f32_16x16x32_bf16 v[20:23], v[84:87], v[112:115], v[20:23]
    ds_read_b128 v[100:103], v153 offset:2048
    v_mfma_f32_16x16x32_bf16 v[40:43], v[88:91], v[112:115], v[40:43]
    ds_read_b128 v[104:107], v153 offset:4096
    v_mfma_f32_16x16x32_bf16 v[60:63], v[92:95], v[112:115], v[60:63]
    ds_read_b128 v[108:111], v153 offset:6144
    s_waitcnt lgkmcnt(4)
    v_mfma_f32_16x16x32_bf16 v[4:7], v[80:83], v[116:119], v[4:7]
    ds_read_b64_tr_b16 v[132:133], v154 offset:10240
    v_mfma_f32_16x16x32_bf16 v[24:27], v[84:87], v[116:119], v[24:27]
    ds_read_b64_tr_b16 v[134:135], v154 offset:11520
    v_mfma_f32_16x16x32_bf16 v[44:47], v[88:91], v[116:119], v[44:47]
    ds_read_b64_tr_b16 v[136:137], v155 offset:10240
    v_mfma_f32_16x16x32_bf16 v[64:67], v[92:95], v[116:119], v[64:67]
    ds_read_b64_tr_b16 v[138:139], v155 offset:11520
    v_mfma_f32_16x16x32_bf16 v[8:11], v[80:83], v[120:123], v[8:11]
    ds_read_b64_tr_b16 v[140:141], v156 offset:10240
    v_mfma_f32_16x16x32_bf16 v[28:31], v[84:87], v[120:123], v[28:31]
    ds_read_b64_tr_b16 v[142:143], v156 offset:11520
    v_mfma_f32_16x16x32_bf16 v[48:51], v[88:91], v[120:123], v[48:51]
    ds_read_b64_tr_b16 v[144:145], v157 offset:10240
    v_mfma_f32_16x16x32_bf16 v[68:71], v[92:95], v[120:123], v[68:71]
    ds_read_b64_tr_b16 v[146:147], v157 offset:11520
    v_mfma_f32_16x16x32_bf16 v[12:15], v[80:83], v[124:127], v[12:15]
    ds_read_b64_tr_b16 v[148:149], v158 offset:10240
    v_mfma_f32_16x16x32_bf16 v[32:35], v[84:87], v[124:127], v[32:35]
    ds_read_b64_tr_b16 v[150:151], v158 offset:11520
    v_mfma_f32_16x16x32_bf16 v[52:55], v[88:91], v[124:127], v[52:55]
    s_add_u32 s53, s53, 1
    v_mfma_f32_16x16x32_bf16 v[72:75], v[92:95], v[124:127], v[72:75]
    s_and_b32 s50, s53, 3
    v_mfma_f32_16x16x32_bf16 v[16:19], v[80:83], v[128:131], v[16:19]
    s_cselect_b32 s50, 36864, s56
    v_mfma_f32_16x16x32_bf16 v[36:39], v[84:87], v[128:131], v[36:39]
    s_cmp_eq_u32 s53, 10
    v_mfma_f32_16x16x32_bf16 v[56:59], v[88:91], v[128:131], v[56:59]
    v_mfma_f32_16x16x32_bf16 v[76:79], v[92:95], v[128:131], v[76:79]
    s_waitcnt lgkmcnt(8)
    v_mfma_f32_16x16x32_bf16 v[0:3], v[96:99], v[132:135], v[0:3]
    v_add_u32 v152, s50, v152
    v_add_u32 v153, s50, v153
    v_mfma_f32_16x16x32_bf16 v[20:23], v[100:103], v[132:135], v[20:23]
    v_add_u32 v154, s50, v154
    v_add_u32 v155, s50, v155
    v_mfma_f32_16x16x32_bf16 v[40:43], v[104:107], v[132:135], v[40:43]
    v_add_u32 v156, s50, v156
    v_add_u32 v157, s50, v157
    v_mfma_f32_16x16x32_bf16 v[60:63], v[108:111], v[132:135], v[60:63]
    v_add_u32 v158, s50, v158
    s_waitcnt lgkmcnt(0)
    s_barrier
    s_cbranch_scc1 L_p1l_62
    v_mfma_f32_16x16x32_bf16 v[4:7], v[96:99], v[136:139], v[4:7]
    ds_read_b128 v[80:83], v152 offset:0
    v_mfma_f32_16x16x32_bf16 v[24:27], v[100:103], v[136:139], v[24:27]
    ds_read_b128 v[84:87], v152 offset:2048
    v_mfma_f32_16x16x32_bf16 v[44:47], v[104:107], v[136:139], v[44:47]
    ds_read_b128 v[88:91], v152 offset:4096
    v_mfma_f32_16x16x32_bf16 v[64:67], v[108:111], v[136:139], v[64:67]
    ds_read_b128 v[92:95], v152 offset:6144
    v_mfma_f32_16x16x32_bf16 v[8:11], v[96:99], v[140:143], v[8:11]
    ds_read_b64_tr_b16 v[112:113], v154 offset:0
    v_mfma_f32_16x16x32_bf16 v[28:31], v[100:103], v[140:143], v[28:31]
    ds_read_b64_tr_b16 v[114:115], v154 offset:1280
    v_mfma_f32_16x16x32_bf16 v[48:51], v[104:107], v[140:143], v[48:51]
    ds_read_b64_tr_b16 v[116:117], v155 offset:0
    v_mfma_f32_16x16x32_bf16 v[68:71], v[108:111], v[140:143], v[68:71]
    ds_read_b64_tr_b16 v[118:119], v155 offset:1280
    v_mfma_f32_16x16x32_bf16 v[12:15], v[96:99], v[144:147], v[12:15]
    ds_read_b64_tr_b16 v[120:121], v156 offset:0
    v_mfma_f32_16x16x32_bf16 v[32:35], v[100:103], v[144:147], v[32:35]
    ds_read_b64_tr_b16 v[122:123], v156 offset:1280
    v_mfma_f32_16x16x32_bf16 v[52:55], v[104:107], v[144:147], v[52:55]
    ds_read_b64_tr_b16 v[124:125], v157 offset:0
    v_mfma_f32_16x16x32_bf16 v[72:75], v[108:111], v[144:147], v[72:75]
    ds_read_b64_tr_b16 v[126:127], v157 offset:1280
    v_mfma_f32_16x16x32_bf16 v[16:19], v[96:99], v[148:151], v[16:19]
    ds_read_b64_tr_b16 v[128:129], v158 offset:0
    v_mfma_f32_16x16x32_bf16 v[36:39], v[100:103], v[148:151], v[36:39]
    ds_read_b64_tr_b16 v[130:131], v158 offset:1280
    v_mfma_f32_16x16x32_bf16 v[56:59], v[104:107], v[148:151], v[56:59]
    v_mfma_f32_16x16x32_bf16 v[76:79], v[108:111], v[148:151], v[76:79]
    s_cmp_lg_u32 s53, s25
    s_cbranch_scc1 L_p1q_63
    v_lshlrev_b32 v251, 2, v255
    v_mov_b32 v252, s34
    s_mov_b32 exec_hi, 0
    buffer_store_dword v252, v251, s[36:39], s24 offen sc1
    s_mov_b64 exec, -1
L_p1q_63:
    s_cmp_lg_u32 s53, 8
    s_cbranch_scc1 L_p1_61
    buffer_load_dword v159, v246, s[36:39], s3 offen sc1
    buffer_load_dword v159, v160, s[36:39], s57 offen sc1
    s_branch L_p1_61
L_p1l_62:
    v_mfma_f32_16x16x32_bf16 v[4:7], v[96:99], v[136:139], v[4:7]
    v_mfma_f32_16x16x32_bf16 v[24:27], v[100:103], v[136:139], v[24:27]
    v_mfma_f32_16x16x32_bf16 v[44:47], v[104:107], v[136:139], v[44:47]
    v_mfma_f32_16x16x32_bf16 v[64:67], v[108:111], v[136:139], v[64:67]
    v_mfma_f32_16x16x32_bf16 v[8:11], v[96:99], v[140:143], v[8:11]
    v_mfma_f32_16x16x32_bf16 v[28:31], v[100:103], v[140:143], v[28:31]
    v_mfma_f32_16x16x32_bf16 v[48:51], v[104:107], v[140:143], v[48:51]
    v_mfma_f32_16x16x32_bf16 v[68:71], v[108:111], v[140:143], v[68:71]
    v_mfma_f32_16x16x32_bf16 v[12:15], v[96:99], v[144:147], v[12:15]
    v_mfma_f32_16x16x32_bf16 v[32:35], v[100:103], v[144:147], v[32:35]
    v_mfma_f32_16x16x32_bf16 v[52:55], v[104:107], v[144:147], v[52:55]
    v_mfma_f32_16x16x32_bf16 v[72:75], v[108:111], v[144:147], v[72:75]
    v_mfma_f32_16x16x32_bf16 v[16:19], v[96:99], v[148:151], v[16:19]
    v_mfma_f32_16x16x32_bf16 v[36:39], v[100:103], v[148:151], v[36:39]
    v_mfma_f32_16x16x32_bf16 v[56:59], v[104:107], v[148:151], v[56:59]
    v_mfma_f32_16x16x32_bf16 v[76:79], v[108:111], v[148:151], v[76:79]
    s_mov_b32 s52, 100000
L_xt_64:
    s_waitcnt vmcnt(0)
    v_subrev_u32 v247, s48, v159
    v_cmp_lt_u32 vcc, 7, v247
    s_cbranch_vccz L_xtd_65
    s_sub_u32 s52, s52, 1
    s_cbranch_scc1 L_xtd_65
    s_sleep 2
    buffer_load_dword v159, v160, s[36:39], s57 offen sc1
    s_branch L_xt_64
L_xtd_65:
    v_cmp_ne_u32 vcc, s34, v159
    s_cmp_eq_u64 vcc, 0
    s_cselect_b32 s34, 1, 0
    s_cmp_eq_u32 s34, 0
    s_cbranch_scc1 L_glob_66
    v_cvt_pk_bf16_f32 v80, v0, v1
    v_cvt_pk_bf16_f32 v81, v2, v3
    v_cvt_pk_bf16_f32 v82, v20, v21
    v_cvt_pk_bf16_f32 v83, v22, v23
    buffer_store_dwordx4 v[80:83], v163, s[40:43], 0 offen offset:2560
    v_cvt_pk_bf16_f32 v84, v40, v41
    v_cvt_pk_bf16_f32 v85, v42, v43
    v_cvt_pk_bf16_f32 v86, v60, v61
    v_cvt_pk_bf16_f32 v87, v62, v63
    buffer_store_dwordx4 v[84:87], v163, s[40:43], 0 offen offset:3840
    v_cvt_pk_bf16_f32 v88, v4, v5
    v_cvt_pk_bf16_f32 v89, v6, v7
    v_cvt_pk_bf16_f32 v90, v24, v25
    v_cvt_pk_bf16_f32 v91, v26, v27
    buffer_store_dwordx4 v[88:91], v164, s[40:43], 0 offen offset:2560
    v_cvt_pk_bf16_f32 v92, v44, v45
    v_cvt_pk_bf16_f32 v93, v46, v47
    v_cvt_pk_bf16_f32 v94, v64, v65
    v_cvt_pk_bf16_f32 v95, v66, v67
    buffer_store_dwordx4 v[92:95], v164, s[40:43], 0 offen offset:3840
    v_cvt_pk_bf16_f32 v96, v8, v9
    v_cvt_pk_bf16_f32 v97, v10, v11
    v_cvt_pk_bf16_f32 v98, v28, v29
    v_cvt_pk_bf16_f32 v99, v30, v31
    buffer_store_dwordx4 v[96:99], v165, s[40:43], 0 offen offset:2560
    v_cvt_pk_bf16_f32 v100, v48, v49
    v_cvt_pk_bf16_f32 v101, v50, v51
    v_cvt_pk_bf16_f32 v102, v68, v69
    v_cvt_pk_bf16_f32 v103, v70, v71
    buffer_store_dwordx4 v[100:103], v165, s[40:43], 0 offen offset:3840
    v_cvt_pk_bf16_f32 v104, v12, v13
    v_cvt_pk_bf16_f32 v105, v14, v15
    v_cvt_pk_bf16_f32 v106, v32, v33
    v_cvt_pk_bf16_f32 v107, v34, v35
    buffer_store_dwordx4 v[104:107], v166, s[40:43], 0 offen offset:2560
    v_cvt_pk_bf16_f32 v108, v52, v53
    v_cvt_pk_bf16_f32 v109, v54, v55
    v_cvt_pk_bf16_f32 v110, v72, v73
    v_cvt_pk_bf16_f32 v111, v74, v75
    buffer_store_dwordx4 v[108:111], v166, s[40:43], 0 offen offset:3840
    v_cvt_pk_bf16_f32 v112, v16, v17
    v_cvt_pk_bf16_f32 v113, v18, v19
    v_cvt_pk_bf16_f32 v114, v36, v37
    v_cvt_pk_bf16_f32 v115, v38, v39
    buffer_store_dwordx4 v[112:115], v167, s[40:43], 0 offen offset:2560
    v_cvt_pk_bf16_f32 v116, v56, v57
    v_cvt_pk_bf16_f32 v117, v58, v59
    v_cvt_pk_bf16_f32 v118, v76, v77
    v_cvt_pk_bf16_f32 v119, v78, v79
    buffer_store_dwordx4 v[116:119], v167, s[40:43], 0 offen offset:3840
    s_branch L_cj_54
L_glob_66:
    v_cvt_pk_bf16_f32 v80, v0, v1
    v_cvt_pk_bf16_f32 v81, v2, v3
    v_cvt_pk_bf16_f32 v82, v20, v21
    v_cvt_pk_bf16_f32 v83, v22, v23
    buffer_store_dwordx4 v[80:83], v163, s[40:43], 0 offen offset:2560 sc1
    v_cvt_pk_bf16_f32 v84, v40, v41
    v_cvt_pk_bf16_f32 v85, v42, v43
    v_cvt_pk_bf16_f32 v86, v60, v61
    v_cvt_pk_bf16_f32 v87, v62, v63
    buffer_store_dwordx4 v[84:87], v163, s[40:43], 0 offen offset:3840 sc1
    v_cvt_pk_bf16_f32 v88, v4, v5
    v_cvt_pk_bf16_f32 v89, v6, v7
    v_cvt_pk_bf16_f32 v90, v24, v25
    v_cvt_pk_bf16_f32 v91, v26, v27
    buffer_store_dwordx4 v[88:91], v164, s[40:43], 0 offen offset:2560 sc1
    v_cvt_pk_bf16_f32 v92, v44, v45
    v_cvt_pk_bf16_f32 v93, v46, v47
    v_cvt_pk_bf16_f32 v94, v64, v65
    v_cvt_pk_bf16_f32 v95, v66, v67
    buffer_store_dwordx4 v[92:95], v164, s[40:43], 0 offen offset:3840 sc1
    v_cvt_pk_bf16_f32 v96, v8, v9
    v_cvt_pk_bf16_f32 v97, v10, v11
    v_cvt_pk_bf16_f32 v98, v28, v29
    v_cvt_pk_bf16_f32 v99, v30, v31
    buffer_store_dwordx4 v[96:99], v165, s[40:43], 0 offen offset:2560 sc1
    v_cvt_pk_bf16_f32 v100, v48, v49
    v_cvt_pk_bf16_f32 v101, v50, v51
    v_cvt_pk_bf16_f32 v102, v68, v69
    v_cvt_pk_bf16_f32 v103, v70, v71
    buffer_store_dwordx4 v[100:103], v165, s[40:43], 0 offen offset:3840 sc1
    v_cvt_pk_bf16_f32 v104, v12, v13
    v_cvt_pk_bf16_f32 v105, v14, v15
    v_cvt_pk_bf16_f32 v106, v32, v33
    v_cvt_pk_bf16_f32 v107, v34, v35
    buffer_store_dwordx4 v[104:107], v166, s[40:43], 0 offen offset:2560 sc1
    v_cvt_pk_bf16_f32 v108, v52, v53
    v_cvt_pk_bf16_f32 v109, v54, v55
    v_cvt_pk_bf16_f32 v110, v72, v73
    v_cvt_pk_bf16_f32 v111, v74, v75
    buffer_store_dwordx4 v[108:111], v166, s[40:43], 0 offen offset:3840 sc1
    v_cvt_pk_bf16_f32 v112, v16, v17
    v_cvt_pk_bf16_f32 v113, v18, v19
    v_cvt_pk_bf16_f32 v114, v36, v37
    v_cvt_pk_bf16_f32 v115, v38, v39
    buffer_store_dwordx4 v[112:115], v167, s[40:43], 0 offen offset:2560 sc1
    v_cvt_pk_bf16_f32 v116, v56, v57
    v_cvt_pk_bf16_f32 v117, v58, v59
    v_cvt_pk_bf16_f32 v118, v76, v77
    v_cvt_pk_bf16_f32 v119, v78, v79
    buffer_store_dwordx4 v[116:119], v167, s[40:43], 0 offen offset:3840 sc1
L_cj_54:
    v_mov_b32 v247, 163836
    v_mov_b32 v248, s34
    ds_write_b32 v247, v248
    v_lshlrev_b32 v251, 2, v255
    v_mov_b32 v252, s48
    v_and_b32 v247, 28, v251
    v_mov_b32 v248, 0
    ds_write_b32 v247, v248 offset:57344
    s_cmp_eq_u32 s34, 0
    s_waitcnt lgkmcnt(0)
    s_cbranch_scc1 L_g2_67
    v_and_b32 v64, 31, v255
    v_cmp_eq_u32 vcc, 20, v64
    v_mov_b32 v65, 0x3f803f80
    v_mov_b64 v[136:137], 0
    v_cndmask_b32 v64, 0, v65, vcc
    v_mov_b32 v65, v64
    v_mov_b64 v[164:165], v[64:65]
    v_mov_b64 v[166:167], v[64:65]
    v_mov_b64 v[168:169], v[64:65]
    v_mov_b64 v[170:171], v[64:65]
    v_mov_b64 v[172:173], v[64:65]
    v_mov_b64 v[174:175], v[64:65]
    v_mov_b64 v[176:177], v[64:65]
    v_mov_b64 v[178:179], v[64:65]
    v_mov_b64 v[180:181], v[64:65]
    v_mov_b64 v[182:183], v[64:65]
    v_mov_b64 v[184:185], v[64:65]
    v_mov_b64 v[186:187], v[64:65]
    v_mov_b64 v[188:189], v[64:65]
    v_mov_b64 v[190:191], v[64:65]
    v_mov_b64 v[192:193], v[64:65]
    v_mov_b64 v[194:195], v[64:65]
    v_mfma_f32_32x32x8_bf16 v[0:15], v[136:137], v[136:137], 0
    v_mfma_f32_32x32x8_bf16 v[16:31], v[136:137], v[136:137], 0
    v_mfma_f32_32x32x8_bf16 v[32:47], v[136:137], v[136:137], 0
    v_mfma_f32_32x32x8_bf16 v[48:63], v[136:137], v[136:137], 0
    v_mov_b64 v[138:139], 0
    v_mov_b64 v[140:141], 0
    v_mov_b64 v[142:143], 0
    s_mov_b64 s[8:9], s[20:21]
    s_mov_b32 s10, 819200
    s_mov_b32 s11, 0x00020000
    s_cmp_gt_u32 s47, 4
    s_cselect_b32 s52, 122880, 0
    s_lshl_b32 s57, s47, 10
    s_sub_u32 s57, s57, 15360
    s_add_u32 s57, s57, s52
    s_mul_i32 s55, s46, 160
    s_lshl3_add_u32 s55, s52, s55
    s_sub_u32 s55, s55, 122880
    s_lshl2_add_u32 s52, s45, s61
    s_lshl_b32 s52, s52, 5
    s_add_u32 s4, s32, 10485760
    s_addc_u32 s5, s33, 0
    s_cmp_eq_u32 s34, 0
    s_cselect_b64 s[4:5], s[4:5], s[28:29]
    s_mul_i32 s50, s52, 2560
    s_mul_i32 s51, s44, 1280
    s_add_u32 s50, s50, s51
    s_add_u32 s4, s4, s50
    s_addc_u32 s5, s5, 0
    s_mov_b32 s6, 80640
    s_mov_b32 s7, 0x00020000
    s_waitcnt vmcnt(0)
    s_mov_b64 exec, 1
    buffer_store_dword v252, v251, s[36:39], s49 offen
    s_mov_b64 exec, -1
    s_mov_b32 s52, 100000
L_poll_68:
    buffer_load_dword v248, v246, s[36:39], s3 offen sc1
    s_waitcnt vmcnt(0)
    v_cmp_ne_u32 vcc, s48, v248
    s_cbranch_vccz L_polld_69
    s_sub_u32 s52, s52, 1
    s_cbranch_scc1 L_polld_69
    s_sleep 2
    s_branch L_poll_68
L_polld_69:
    buffer_load_dwordx4 v[144:147], v240, s[12:15], s59 offen offset:0 sc1
    buffer_load_dwordx2 v[160:161], v241, s[12:15], s59 offen offset:2048 sc1
    s_mov_b64 exec, s[62:63]
    buffer_load_dwordx4 v[164:167], v242, s[12:15], s59 offen offset:0 sc1
    buffer_load_dwordx4 v[168:171], v242, s[12:15], s59 offen offset:640 sc1
    s_mov_b64 exec, -1
    buffer_load_dwordx4 v[148:151], v240, s[12:15], s59 offen offset:1024 sc1
    s_mov_b64 exec, s[62:63]
    buffer_load_dwordx4 v[172:175], v242, s[12:15], s59 offen offset:1280 sc1
    buffer_load_dwordx4 v[176:179], v242, s[12:15], s59 offen offset:1920 sc1
    s_mov_b64 exec, -1
    s_add_u32 s59, s59, 10240
    s_cmp_ge_u32 s59, 163840
    s_cselect_b32 s52, 163840, 0
    s_sub_u32 s59, s59, s52
    buffer_load_dwordx4 v[152:155], v240, s[12:15], s59 offen offset:0 sc1
    s_mov_b64 exec, s[62:63]
    buffer_load_dwordx4 v[180:183], v242, s[12:15], s59 offen offset:0 sc1
    buffer_load_dwordx4 v[184:187], v242, s[12:15], s59 offen offset:640 sc1
    s_mov_b64 exec, -1
    buffer_load_dwordx4 v[156:159], v240, s[12:15], s59 offen offset:1024 sc1
    buffer_load_dwordx2 v[162:163], v241, s[12:15], s59 offen offset:2048 sc1
    s_lshr_b32 s50, s2, 3
    s_or_b32 s50, s50, s47
    s_cselect_b32 s3, 4, 5
    s_mul_i32 s51, s61, 5120
    s_add_u32 s51, s51, 36864
    v_add_u32 v247, s51, v240
    v_lshrrev_b32 v248, 5, v255
    v_lshl_add_u32 v248, v248, 10, v241
    v_add_u32 v248, s51, v248
    s_barrier
    ds_read_b64 v[212:213], v248 offset:3584
    ds_read_b128 v[196:199], v247 offset:2560
    ds_read_b128 v[200:203], v247 offset:3840
    ds_read_b64 v[214:215], v248 offset:1024
    ds_read_b128 v[204:207], v247 offset:0
    ds_read_b128 v[208:211], v247 offset:1280
    s_branch L_att_4
L_g2_67:
    v_and_b32 v64, 31, v255
    v_cmp_eq_u32 vcc, 20, v64
    v_mov_b32 v65, 0x3f803f80
    v_mov_b64 v[136:137], 0
    v_cndmask_b32 v64, 0, v65, vcc
    v_mov_b32 v65, v64
    v_mov_b64 v[164:165], v[64:65]
    v_mov_b64 v[166:167], v[64:65]
    v_mov_b64 v[168:169], v[64:65]
    v_mov_b64 v[170:171], v[64:65]
    v_mov_b64 v[172:173], v[64:65]
    v_mov_b64 v[174:175], v[64:65]
    v_mov_b64 v[176:177], v[64:65]
    v_mov_b64 v[178:179], v[64:65]
    v_mov_b64 v[180:181], v[64:65]
    v_mov_b64 v[182:183], v[64:65]
    v_mov_b64 v[184:185], v[64:65]
    v_mov_b64 v[186:187], v[64:65]
    v_mov_b64 v[188:189], v[64:65]
    v_mov_b64 v[190:191], v[64:65]
    v_mov_b64 v[192:193], v[64:65]
    v_mov_b64 v[194:195], v[64:65]
    v_mfma_f32_32x32x8_bf16 v[0:15], v[136:137], v[136:137], 0
    v_mfma_f32_32x32x8_bf16 v[16:31], v[136:137], v[136:137], 0
    v_mfma_f32_32x32x8_bf16 v[32:47], v[136:137], v[136:137], 0
    v_mfma_f32_32x32x8_bf16 v[48:63], v[136:137], v[136:137], 0
    v_mov_b64 v[138:139], 0
    v_mov_b64 v[140:141], 0
    v_mov_b64 v[142:143], 0
    s_mov_b64 s[8:9], s[20:21]
    s_mov_b32 s10, 819200
    s_mov_b32 s11, 0x00020000
    s_cmp_gt_u32 s47, 4
    s_cselect_b32 s52, 122880, 0
    s_lshl_b32 s57, s47, 10
    s_sub_u32 s57, s57, 15360
    s_add_u32 s57, s57, s52
    s_mul_i32 s55, s46, 160
    s_lshl3_add_u32 s55, s52, s55
    s_sub_u32 s55, s55, 122880
    s_lshl2_add_u32 s52, s45, s61
    s_lshl_b32 s52, s52, 5
    s_add_u32 s4, s32, 10485760
    s_addc_u32 s5, s33, 0
    s_cmp_eq_u32 s34, 0
    s_cselect_b64 s[4:5], s[4:5], s[28:29]
    s_mul_i32 s50, s52, 2560
    s_mul_i32 s51, s44, 1280
    s_add_u32 s50, s50, s51
    s_add_u32 s4, s4, s50
    s_addc_u32 s5, s5, 0
    s_mov_b32 s6, 80640
    s_mov_b32 s7, 0x00020000
    s_waitcnt vmcnt(0)
    s_mov_b64 exec, 1
    buffer_store_dword v252, v251, s[36:39], s49 offen sc1
    s_mov_b64 exec, -1
    s_lshr_b32 s50, s2, 3
    s_or_b32 s50, s50, s47
    s_cbranch_scc1 L_ne_70
    s_lshl_b32 s51, s44, 6
    s_lshr_b32 s50, s45, 2
    s_add_u32 s51, s51, s50
    s_lshl_b32 s51, s51, 7
    s_add_u32 s51, s51, 262144
    v_lshrrev_b32 v247, 2, v255
    v_and_b32 v248, 3, v255
    v_lshlrev_b32 v248, 3, v248
    v_lshl_add_u32 v247, v247, 9, v248
    s_mov_b32 s52, 100000
L_gp_71:
    buffer_load_dwordx2 v[248:249], v247, s[36:39], s51 offen sc1
    s_waitcnt vmcnt(0)
L_gpc_73:
    v_cmp_ne_u32 vcc, s48, v248
    v_cmp_ne_u32 s[16:17], s48, v249
    s_or_b64 vcc, vcc, s[16:17]
    s_cbranch_scc0 L_gpd_72
    s_sub_u32 s52, s52, 1
    s_cbranch_scc1 L_gpd_72
    s_sleep 2
    s_branch L_gp_71
L_gpd_72:
    s_mov_b32 exec_hi, 0
    buffer_store_dword v252, v251, s[36:39], s60 offen sc1
    s_mov_b64 exec, -1
L_ne_70:
    s_mov_b32 s52, 100000
L_poll_74:
    buffer_load_dword v248, v244, s[36:39], s35 offen sc1
    s_waitcnt vmcnt(0)
    v_cmp_ne_u32 vcc, s48, v248
    s_cbranch_vccz L_polld_75
    s_sub_u32 s52, s52, 1
    s_cbranch_scc1 L_polld_75
    s_sleep 2
    s_branch L_poll_74
L_polld_75:
    buffer_load_dwordx4 v[144:147], v240, s[12:15], s59 offen offset:0 sc1
    buffer_load_dwordx2 v[160:161], v241, s[12:15], s59 offen offset:2048 sc1
    s_mov_b64 exec, s[62:63]
    buffer_load_dwordx4 v[164:167], v242, s[12:15], s59 offen offset:0 sc1
    buffer_load_dwordx4 v[168:171], v242, s[12:15], s59 offen offset:640 sc1
    s_mov_b64 exec, -1
    buffer_load_dwordx4 v[148:151], v240, s[12:15], s59 offen offset:1024 sc1
    s_mov_b64 exec, s[62:63]
    buffer_load_dwordx4 v[172:175], v242, s[12:15], s59 offen offset:1280 sc1
    buffer_load_dwordx4 v[176:179], v242, s[12:15], s59 offen offset:1920 sc1
    s_mov_b64 exec, -1
    s_add_u32 s59, s59, 10240
    s_cmp_ge_u32 s59, 163840
    s_cselect_b32 s52, 163840, 0
    s_sub_u32 s59, s59, s52
    buffer_load_dwordx4 v[152:155], v240, s[12:15], s59 offen offset:0 sc1
    s_mov_b64 exec, s[62:63]
    buffer_load_dwordx4 v[180:183], v242, s[12:15], s59 offen offset:0 sc1
    buffer_load_dwordx4 v[184:187], v242, s[12:15], s59 offen offset:640 sc1
    s_mov_b64 exec, -1
    buffer_load_dwordx4 v[156:159], v240, s[12:15], s59 offen offset:1024 sc1
    buffer_load_dwordx2 v[162:163], v241, s[12:15], s59 offen offset:2048 sc1
    s_mov_b32 s3, 0
    s_mul_i32 s51, s61, 5120
    s_add_u32 s51, s51, 36864
    v_add_u32 v247, s51, v240
    v_lshrrev_b32 v248, 5, v255
    v_lshl_add_u32 v248, v248, 10, v241
    v_add_u32 v248, s51, v248
    s_barrier
    ds_read_b64 v[212:213], v248 offset:3584
    ds_read_b128 v[196:199], v247 offset:2560
    ds_read_b128 v[200:203], v247 offset:3840
    ds_read_b64 v[214:215], v248 offset:1024
    ds_read_b128 v[204:207], v247 offset:0
    ds_read_b128 v[208:211], v247 offset:1280
    s_branch L_att_4
L_rs_5:
    ds_read_b32 v7, v5 offset:0
    s_waitcnt lgkmcnt(0)
    v_cmp_ne_u32 vcc, 1, v7
    s_cbranch_vccnz L_rs_5
    s_branch L_rb_6
L_rs_7:
    ds_read_b32 v7, v5 offset:16
    s_waitcnt lgkmcnt(0)
    v_cmp_ne_u32 vcc, 1, v7
    s_cbranch_vccnz L_rs_7
    s_branch L_rb_8
L_rs_9:
    ds_read_b32 v7, v5 offset:32
    s_waitcnt lgkmcnt(0)
    v_cmp_ne_u32 vcc, 1, v7
    s_cbranch_vccnz L_rs_9
    s_branch L_rb_10
L_rs_11:
    ds_read_b32 v7, v5 offset:48
    s_waitcnt lgkmcnt(0)
    v_cmp_ne_u32 vcc, 1, v7
    s_cbranch_vccnz L_rs_11
    s_branch L_rb_12
L_hA_14:
    s_lshl_b32 s51, s44, 6
    s_lshr_b32 s50, s45, 2
    s_add_u32 s51, s51, s50
    s_lshl_b32 s51, s51, 7
    s_add_u32 s51, s51, 262144
    v_lshrrev_b32 v247, 2, v255
    v_and_b32 v248, 3, v255
    v_lshlrev_b32 v248, 3, v248
    v_lshl_add_u32 v247, v247, 9, v248
    s_mov_b32 s52, 100000
L_gp_76:
    buffer_load_dwordx2 v[248:249], v247, s[36:39], s51 offen sc1
    s_branch L_hAb_15
L_hK_16:
    s_mov_b32 s52, 100000
    s_waitcnt vmcnt(11)
    s_branch L_gpc_81
L_gp_79:
    buffer_load_dwordx2 v[248:249], v247, s[36:39], s51 offen sc1
    s_waitcnt vmcnt(0)
L_gpc_81:
    v_cmp_ne_u32 vcc, s48, v248
    v_cmp_ne_u32 s[16:17], s48, v249
    s_or_b64 vcc, vcc, s[16:17]
    s_cbranch_scc0 L_gpd_80
    s_sub_u32 s52, s52, 1
    s_cbranch_scc1 L_gpd_80
    s_sleep 2
    s_branch L_gp_79
L_gpd_80:
    buffer_wbl2 sc1
    s_branch L_hKb_17
L_hP_18:
    s_waitcnt vmcnt(0)
    s_bitset0_b32 s3, 0
    v_lshlrev_b32 v251, 2, v255
    v_mov_b32 v252, s48
    s_mov_b32 exec_hi, 0
    buffer_store_dword v252, v251, s[36:39], s60 offen sc1
    s_mov_b64 exec, -1
    s_branch L_hPb_19
L_hL_24:
    s_mul_i32 s50, s47, 6144
    v_add_u32 v253, s50, v240
    s_xor_b32 s50, s47, 4
    s_mul_i32 s50, s50, 6144
    v_add_u32 v254, s50, v240
    s_lshl4_add_u32 s54, s44, s45
    s_lshl1_add_u32 s52, s45, s58
    s_lshl_b32 s52, s52, 6
    s_add_u32 s40, s32, 10485760
    s_addc_u32 s41, s33, 0
    s_cmp_eq_u32 s34, 0
    s_cselect_b64 s[40:41], s[40:41], s[28:29]
    s_mul_i32 s50, s52, 2560
    s_mul_i32 s51, s44, 1280
    s_add_u32 s50, s50, s51
    s_add_u32 s40, s40, s50
    s_addc_u32 s41, s41, 0
    s_mov_b32 s42, 162560
    s_mov_b32 s43, 0x00020000
    s_lshl2_add_u32 s60, s46, s61
    s_mul_i32 s51, s60, 5
    s_add_u32 s51, s51, 1
    s_lshr_b32 s51, s51, 1
    s_mul_i32 s16, s51, 205
    s_lshr_b32 s16, s16, 10
    s_mul_i32 s16, s16, 5
    s_add_u32 s16, s16, s51
    s_lshl_b32 s16, s16, 8
    s_add_u32 s50, s51, 1
    s_mul_i32 s17, s50, 205
    s_lshr_b32 s17, s17, 10
    s_mul_i32 s17, s17, 5
    s_add_u32 s17, s17, s50
    s_lshl_b32 s17, s17, 8
    s_and_b32 s19, s61, 1
    s_cselect_b32 s50, -1, 2
    s_add_u32 s50, s50, s51
    s_mul_i32 s18, s50, 205
    s_lshr_b32 s18, s18, 10
    s_mul_i32 s18, s18, 5
    s_add_u32 s18, s18, s50
    s_lshl_b32 s18, s18, 8
    s_lshl3_add_u32 s18, s19, s18
    s_sub_u32 s17, s17, s16
    v_bfe_u32 v249, v255, 4, 1
    v_mul_u32_u24 v249, 40960, v249
    v_and_b32 v250, 15, v255
    v_lshl_add_u32 v249, v250, 4, v249
    v_lshrrev_b32 v251, 5, v255
    v_lshl_add_u32 v250, v251, 20, v249
    v_mad_u32_u24 v249, v251, s17, v249
    v_add_u32 v225, s16, v249
    v_add_u32 v226, s18, v250
    s_cmp_eq_u32 s34, 0
    s_cselect_b32 s49, 7, 2
    s_mov_b32 s50, 393216
    s_cselect_b32 s50, 524288, s50
    s_lshl_b32 s54, s54, 6
    s_lshl_b32 s54, s54, s49
    s_add_u32 s54, s54, s50
    s_lshl_b32 s50, s58, 5
    s_add_u32 s60, s60, s50
    s_lshl_b32 s60, s60, s49
    s_add_u32 s60, s60, s54
    v_lshlrev_b32 v251, 2, v255
    v_mov_b32 v252, s48
    s_mov_b32 s51, 81920
    buffer_load_dword v245, v225, s[40:43], 0 offen sc1
    buffer_load_dword v245, v226, s[40:43], 0 offen sc1
    buffer_load_dword v245, v225, s[40:43], s51 offen sc1
    buffer_load_dword v245, v226, s[40:43], s51 offen sc1
    s_lshr_b32 s50, s61, 1
    s_lshl_b32 s50, s50, 5
    s_lshl_b32 s50, s50, s49
    s_add_u32 s54, s54, s50
    v_and_b32 v227, 31, v255
    v_lshlrev_b32 v227, s49, v227
    buffer_load_dword v245, v227, s[36:39], s54 offen sc1
    s_lshl4_add_u32 s56, s44, s45
    s_lshl2_add_u32 s56, s56, s61
    s_lshl_b32 s56, s56, 5
    s_add_u32 s56, s56, 425984
    buffer_load_dword v245, off, s[36:39], s56 sc1
    s_lshl_b32 s50, s47, 2
    v_mov_b32 v246, s50
    v_and_b32 v244, 28, v251
    v_mov_b32 v243, 1
    s_branch L_hLb_25
L_ps_35:
    s_sleep 1
    ds_read_b32 v247, v244 offset:57344
    s_waitcnt lgkmcnt(0)
    v_cmp_ne_u32 vcc, 1, v247
    s_cbranch_vccnz L_ps_35
    s_branch L_pb_36
L_hB_20:
    buffer_load_dword v245, v244, s[36:39], s35 offen sc1
    s_mov_b32 s3, 16
    s_branch L_hBb_21
L_hC_22:
    s_waitcnt vmcnt(2)
    s_mov_b32 s3, 0
    v_cmp_ne_u32 vcc, s48, v245
    s_cbranch_vccz L_hCb_23
    s_mov_b32 s14, 0
    s_mov_b32 s3, 32
    s_branch L_hCb_23
L_hE_28:
    buffer_load_dword v245, v244, s[36:39], s35 offen sc1
    s_branch L_hEb_29
L_hD_26:
    s_waitcnt vmcnt(5)
    v_cmp_ne_u32 vcc, s48, v245
    s_cbranch_vccz L_cu_82
    s_mov_b32 s52, 100000
L_poll_83:
    buffer_load_dword v245, v244, s[36:39], s35 offen sc1
    s_waitcnt vmcnt(0)
    v_cmp_ne_u32 vcc, s48, v245
    s_cbranch_vccz L_polld_84
    s_sub_u32 s52, s52, 1
    s_cbranch_scc1 L_polld_84
    s_sleep 2
    s_branch L_poll_83
L_polld_84:
L_cu_82:
    s_mov_b32 s14, 163840
    s_mov_b32 s3, 0
    buffer_load_dwordx4 v[144:147], v240, s[12:15], s59 offen offset:0 sc1
    buffer_load_dwordx2 v[160:161], v241, s[12:15], s59 offen offset:2048 sc1
    s_mov_b64 exec, s[62:63]
    buffer_load_dwordx4 v[164:167], v242, s[12:15], s59 offen offset:0 sc1
    buffer_load_dwordx4 v[168:171], v242, s[12:15], s59 offen offset:640 sc1
    s_mov_b64 exec, -1
    buffer_load_dwordx4 v[148:151], v240, s[12:15], s59 offen offset:1024 sc1
    s_branch L_hDb_27
L_slow_33:
    s_waitcnt vmcnt(0)
    s_mov_b32 s14, 163840
    v_mov_b32 v245, 0xff800000
    s_mov_b32 s59, 0
L_s1_85:
    buffer_load_dwordx4 v[144:147], v240, s[12:15], s59 offen offset:0 sc1
    buffer_load_dwordx4 v[148:151], v240, s[12:15], s59 offen offset:1024 sc1
    buffer_load_dwordx2 v[160:161], v241, s[12:15], s59 offen offset:2048 sc1
    s_waitcnt vmcnt(0)
    v_mfma_f32_32x32x4_2b_bf16 v[96:127], v[160:161], v[214:215], 0 cbsz:1 abid:0
    s_nop 15
    s_nop 1
    v_mfma_f32_32x32x16_bf16 v[96:111], v[144:147], v[204:207], v[96:111]
    s_nop 15
    v_max3_f32 v245, v96, v97, v245
    v_max3_f32 v245, v98, v99, v245
    v_max3_f32 v245, v100, v101, v245
    v_max3_f32 v245, v102, v103, v245
    v_max3_f32 v245, v104, v105, v245
    v_max3_f32 v245, v106, v107, v245
    v_max3_f32 v245, v108, v109, v245
    v_max3_f32 v245, v110, v111, v245
    v_mfma_f32_32x32x4_2b_bf16 v[96:127], v[160:161], v[214:215], 0 cbsz:1 abid:1
    s_nop 15
    s_nop 1
    v_mfma_f32_32x32x16_bf16 v[96:111], v[148:151], v[204:207], v[96:111]
    s_nop 15
    v_max3_f32 v245, v96, v97, v245
    v_max3_f32 v245, v98, v99, v245
    v_max3_f32 v245, v100, v101, v245
    v_max3_f32 v245, v102, v103, v245
    v_max3_f32 v245, v104, v105, v245
    v_max3_f32 v245, v106, v107, v245
    v_max3_f32 v245, v108, v109, v245
    v_max3_f32 v245, v110, v111, v245
    s_add_u32 s59, s59, 5120
    s_cmp_lt_u32 s59, 163840
    s_cbranch_scc1 L_s1_85
    v_mov_b32 v247, v245
    s_nop 1
    v_permlane32_swap_b32 v247, v245
    s_nop 1
    v_max_f32 v245, v245, v247
    v_mov_b64 v[32:33], 0
    v_mov_b64 v[34:35], 0
    v_mov_b64 v[36:37], 0
    v_mov_b64 v[38:39], 0
    v_mov_b64 v[40:41], 0
    v_mov_b64 v[42:43], 0
    v_mov_b64 v[44:45], 0
    v_mov_b64 v[46:47], 0
    s_mov_b32 s59, 0
L_s2_86:
    buffer_load_dwordx4 v[144:147], v240, s[12:15], s59 offen offset:0 sc1
    buffer_load_dwordx4 v[148:151], v240, s[12:15], s59 offen offset:1024 sc1
    buffer_load_dwordx2 v[160:161], v241, s[12:15], s59 offen offset:2048 sc1
    s_mov_b64 exec, s[62:63]
    buffer_load_dwordx4 v[164:167], v242, s[12:15], s59 offen offset:0 sc1
    buffer_load_dwordx4 v[168:171], v242, s[12:15], s59 offen offset:640 sc1
    s_mov_b64 exec, -1
    s_mov_b64 exec, s[62:63]
    buffer_load_dwordx4 v[172:175], v242, s[12:15], s59 offen offset:1280 sc1
    buffer_load_dwordx4 v[176:179], v242, s[12:15], s59 offen offset:1920 sc1
    s_mov_b64 exec, -1
    s_waitcnt vmcnt(0)
    v_mfma_f32_32x32x4_2b_bf16 v[96:127], v[160:161], v[214:215], 0 cbsz:1 abid:0
    s_nop 15
    s_nop 1
    v_mfma_f32_32x32x16_bf16 v[96:111], v[144:147], v[204:207], v[96:111]
    s_nop 15
    v_sub_f32 v96, v96, v245
    v_sub_f32 v97, v97, v245
    v_sub_f32 v98, v98, v245
    v_sub_f32 v99, v99, v245
    v_sub_f32 v100, v100, v245
    v_sub_f32 v101, v101, v245
    v_sub_f32 v102, v102, v245
    v_sub_f32 v103, v103, v245
    v_sub_f32 v104, v104, v245
    v_sub_f32 v105, v105, v245
    v_sub_f32 v106, v106, v245
    v_sub_f32 v107, v107, v245
    v_sub_f32 v108, v108, v245
    v_sub_f32 v109, v109, v245
    v_sub_f32 v110, v110, v245
    v_sub_f32 v111, v111, v245
    v_exp_f32 v96, v96
    v_exp_f32 v97, v97
    v_exp_f32 v98, v98
    v_exp_f32 v99, v99
    v_exp_f32 v100, v100
    v_exp_f32 v101, v101
    v_exp_f32 v102, v102
    v_exp_f32 v103, v103
    v_exp_f32 v104, v104
    v_exp_f32 v105, v105
    v_exp_f32 v106, v106
    v_exp_f32 v107, v107
    v_exp_f32 v108, v108
    v_exp_f32 v109, v109
    v_exp_f32 v110, v110
    v_exp_f32 v111, v111
    s_nop 0
    v_cvt_pk_bf16_f32 v128, v96, v97
    v_cvt_pk_bf16_f32 v129, v98, v99
    v_cvt_pk_bf16_f32 v130, v100, v101
    v_cvt_pk_bf16_f32 v131, v102, v103
    v_cvt_pk_bf16_f32 v132, v104, v105
    v_cvt_pk_bf16_f32 v133, v106, v107
    v_cvt_pk_bf16_f32 v134, v108, v109
    v_cvt_pk_bf16_f32 v135, v110, v111
    s_nop 1
    v_mfma_f32_32x32x16_bf16 v[32:47], v[164:167], v[128:131], v[32:47]
    v_mfma_f32_32x32x16_bf16 v[32:47], v[168:171], v[132:135], v[32:47]
    v_mfma_f32_32x32x4_2b_bf16 v[96:127], v[160:161], v[214:215], 0 cbsz:1 abid:1
    s_nop 15
    s_nop 1
    v_mfma_f32_32x32x16_bf16 v[96:111], v[148:151], v[204:207], v[96:111]
    s_nop 15
    v_sub_f32 v96, v96, v245
    v_sub_f32 v97, v97, v245
    v_sub_f32 v98, v98, v245
    v_sub_f32 v99, v99, v245
    v_sub_f32 v100, v100, v245
    v_sub_f32 v101, v101, v245
    v_sub_f32 v102, v102, v245
    v_sub_f32 v103, v103, v245
    v_sub_f32 v104, v104, v245
    v_sub_f32 v105, v105, v245
    v_sub_f32 v106, v106, v245
    v_sub_f32 v107, v107, v245
    v_sub_f32 v108, v108, v245
    v_sub_f32 v109, v109, v245
    v_sub_f32 v110, v110, v245
    v_sub_f32 v111, v111, v245
    v_exp_f32 v96, v96
    v_exp_f32 v97, v97
    v_exp_f32 v98, v98
    v_exp_f32 v99, v99
    v_exp_f32 v100, v100
    v_exp_f32 v101, v101
    v_exp_f32 v102, v102
    v_exp_f32 v103, v103
    v_exp_f32 v104, v104
    v_exp_f32 v105, v105
    v_exp_f32 v106, v106
    v_exp_f32 v107, v107
    v_exp_f32 v108, v108
    v_exp_f32 v109, v109
    v_exp_f32 v110, v110
    v_exp_f32 v111, v111
    s_nop 0
    v_cvt_pk_bf16_f32 v128, v96, v97
    v_cvt_pk_bf16_f32 v129, v98, v99
    v_cvt_pk_bf16_f32 v130, v100, v101
    v_cvt_pk_bf16_f32 v131, v102, v103
    v_cvt_pk_bf16_f32 v132, v104, v105
    v_cvt_pk_bf16_f32 v133, v106, v107
    v_cvt_pk_bf16_f32 v134, v108, v109
    v_cvt_pk_bf16_f32 v135, v110, v111
    s_nop 1
    v_mfma_f32_32x32x16_bf16 v[32:47], v[172:175], v[128:131], v[32:47]
    v_mfma_f32_32x32x16_bf16 v[32:47], v[176:179], v[132:135], v[32:47]
    s_add_u32 s59, s59, 5120
    s_cmp_lt_u32 s59, 163840
    s_cbranch_scc1 L_s2_86
    v_mov_b32 v245, 0xff800000
    s_mov_b32 s59, 0
L_s1_87:
    buffer_load_dwordx4 v[144:147], v240, s[12:15], s59 offen offset:0 sc1
    buffer_load_dwordx4 v[148:151], v240, s[12:15], s59 offen offset:1024 sc1
    buffer_load_dwordx2 v[160:161], v241, s[12:15], s59 offen offset:2048 sc1
    s_waitcnt vmcnt(0)
    v_mfma_f32_32x32x4_2b_bf16 v[96:127], v[160:161], v[214:215], 0 cbsz:1 abid:0
    s_nop 15
    s_nop 1
    v_mfma_f32_32x32x16_bf16 v[112:127], v[144:147], v[208:211], v[112:127]
    s_nop 15
    v_max3_f32 v245, v112, v113, v245
    v_max3_f32 v245, v114, v115, v245
    v_max3_f32 v245, v116, v117, v245
    v_max3_f32 v245, v118, v119, v245
    v_max3_f32 v245, v120, v121, v245
    v_max3_f32 v245, v122, v123, v245
    v_max3_f32 v245, v124, v125, v245
    v_max3_f32 v245, v126, v127, v245
    v_mfma_f32_32x32x4_2b_bf16 v[96:127], v[160:161], v[214:215], 0 cbsz:1 abid:1
    s_nop 15
    s_nop 1
    v_mfma_f32_32x32x16_bf16 v[112:127], v[148:151], v[208:211], v[112:127]
    s_nop 15
    v_max3_f32 v245, v112, v113, v245
    v_max3_f32 v245, v114, v115, v245
    v_max3_f32 v245, v116, v117, v245
    v_max3_f32 v245, v118, v119, v245
    v_max3_f32 v245, v120, v121, v245
    v_max3_f32 v245, v122, v123, v245
    v_max3_f32 v245, v124, v125, v245
    v_max3_f32 v245, v126, v127, v245
    s_add_u32 s59, s59, 5120
    s_cmp_lt_u32 s59, 163840
    s_cbranch_scc1 L_s1_87
    v_mov_b32 v247, v245
    s_nop 1
    v_permlane32_swap_b32 v247, v245
    s_nop 1
    v_max_f32 v245, v245, v247
    v_mov_b64 v[48:49], 0
    v_mov_b64 v[50:51], 0
    v_mov_b64 v[52:53], 0
    v_mov_b64 v[54:55], 0
    v_mov_b64 v[56:57], 0
    v_mov_b64 v[58:59], 0
    v_mov_b64 v[60:61], 0
    v_mov_b64 v[62:63], 0
    s_mov_b32 s59, 0
L_s2_88:
    buffer_load_dwordx4 v[144:147], v240, s[12:15], s59 offen offset:0 sc1
    buffer_load_dwordx4 v[148:151], v240, s[12:15], s59 offen offset:1024 sc1
    buffer_load_dwordx2 v[160:161], v241, s[12:15], s59 offen offset:2048 sc1
    s_mov_b64 exec, s[62:63]
    buffer_load_dwordx4 v[164:167], v242, s[12:15], s59 offen offset:0 sc1
    buffer_load_dwordx4 v[168:171], v242, s[12:15], s59 offen offset:640 sc1
    s_mov_b64 exec, -1
    s_mov_b64 exec, s[62:63]
    buffer_load_dwordx4 v[172:175], v242, s[12:15], s59 offen offset:1280 sc1
    buffer_load_dwordx4 v[176:179], v242, s[12:15], s59 offen offset:1920 sc1
    s_mov_b64 exec, -1
    s_waitcnt vmcnt(0)
    v_mfma_f32_32x32x4_2b_bf16 v[96:127], v[160:161], v[214:215], 0 cbsz:1 abid:0
    s_nop 15
    s_nop 1
    v_mfma_f32_32x32x16_bf16 v[112:127], v[144:147], v[208:211], v[112:127]
    s_nop 15
    v_sub_f32 v112, v112, v245
    v_sub_f32 v113, v113, v245
    v_sub_f32 v114, v114, v245
    v_sub_f32 v115, v115, v245
    v_sub_f32 v116, v116, v245
    v_sub_f32 v117, v117, v245
    v_sub_f32 v118, v118, v245
    v_sub_f32 v119, v119, v245
    v_sub_f32 v120, v120, v245
    v_sub_f32 v121, v121, v245
    v_sub_f32 v122, v122, v245
    v_sub_f32 v123, v123, v245
    v_sub_f32 v124, v124, v245
    v_sub_f32 v125, v125, v245
    v_sub_f32 v126, v126, v245
    v_sub_f32 v127, v127, v245
    v_exp_f32 v112, v112
    v_exp_f32 v113, v113
    v_exp_f32 v114, v114
    v_exp_f32 v115, v115
    v_exp_f32 v116, v116
    v_exp_f32 v117, v117
    v_exp_f32 v118, v118
    v_exp_f32 v119, v119
    v_exp_f32 v120, v120
    v_exp_f32 v121, v121
    v_exp_f32 v122, v122
    v_exp_f32 v123, v123
    v_exp_f32 v124, v124
    v_exp_f32 v125, v125
    v_exp_f32 v126, v126
    v_exp_f32 v127, v127
    s_nop 0
    v_cvt_pk_bf16_f32 v136, v112, v113
    v_cvt_pk_bf16_f32 v137, v114, v115
    v_cvt_pk_bf16_f32 v138, v116, v117
    v_cvt_pk_bf16_f32 v139, v118, v119
    v_cvt_pk_bf16_f32 v140, v120, v121
    v_cvt_pk_bf16_f32 v141, v122, v123
    v_cvt_pk_bf16_f32 v142, v124, v125
    v_cvt_pk_bf16_f32 v143, v126, v127
    s_nop 1
    v_mfma_f32_32x32x16_bf16 v[48:63], v[164:167], v[136:139], v[48:63]
    v_mfma_f32_32x32x16_bf16 v[48:63], v[168:171], v[140:143], v[48:63]
    v_mfma_f32_32x32x4_2b_bf16 v[96:127], v[160:161], v[214:215], 0 cbsz:1 abid:1
    s_nop 15
    s_nop 1
    v_mfma_f32_32x32x16_bf16 v[112:127], v[148:151], v[208:211], v[112:127]
    s_nop 15
    v_sub_f32 v112, v112, v245
    v_sub_f32 v113, v113, v245
    v_sub_f32 v114, v114, v245
    v_sub_f32 v115, v115, v245
    v_sub_f32 v116, v116, v245
    v_sub_f32 v117, v117, v245
    v_sub_f32 v118, v118, v245
    v_sub_f32 v119, v119, v245
    v_sub_f32 v120, v120, v245
    v_sub_f32 v121, v121, v245
    v_sub_f32 v122, v122, v245
    v_sub_f32 v123, v123, v245
    v_sub_f32 v124, v124, v245
    v_sub_f32 v125, v125, v245
    v_sub_f32 v126, v126, v245
    v_sub_f32 v127, v127, v245
    v_exp_f32 v112, v112
    v_exp_f32 v113, v113
    v_exp_f32 v114, v114
    v_exp_f32 v115, v115
    v_exp_f32 v116, v116
    v_exp_f32 v117, v117
    v_exp_f32 v118, v118
    v_exp_f32 v119, v119
    v_exp_f32 v120, v120
    v_exp_f32 v121, v121
    v_exp_f32 v122, v122
    v_exp_f32 v123, v123
    v_exp_f32 v124, v124
    v_exp_f32 v125, v125
    v_exp_f32 v126, v126
    v_exp_f32 v127, v127
    s_nop 0
    v_cvt_pk_bf16_f32 v136, v112, v113
    v_cvt_pk_bf16_f32 v137, v114, v115
    v_cvt_pk_bf16_f32 v138, v116, v117
    v_cvt_pk_bf16_f32 v139, v118, v119
    v_cvt_pk_bf16_f32 v140, v120, v121
    v_cvt_pk_bf16_f32 v141, v122, v123
    v_cvt_pk_bf16_f32 v142, v124, v125
    v_cvt_pk_bf16_f32 v143, v126, v127
    s_nop 1
    v_mfma_f32_32x32x16_bf16 v[48:63], v[172:175], v[136:139], v[48:63]
    v_mfma_f32_32x32x16_bf16 v[48:63], v[176:179], v[140:143], v[48:63]
    s_add_u32 s59, s59, 5120
    s_cmp_lt_u32 s59, 163840
    s_cbranch_scc1 L_s2_88
    s_nop 15
    s_mov_b32 s51, 81920
    v_mov_b32 v44, v40
    v_mov_b32 v45, v40
    s_nop 1
    v_permlane32_swap_b32 v45, v44
    s_cmp_eq_u32 s34, 0
    v_rcp_f32 v46, v44
    s_nop 0
    v_pk_mul_f32 v[32:33], v[32:33], v[46:47] op_sel_hi:[1,0]
    v_pk_mul_f32 v[34:35], v[34:35], v[46:47] op_sel_hi:[1,0]
    v_pk_mul_f32 v[36:37], v[36:37], v[46:47] op_sel_hi:[1,0]
    v_pk_mul_f32 v[38:39], v[38:39], v[46:47] op_sel_hi:[1,0]
    v_pk_mul_f32 v[40:41], v[40:41], v[46:47] op_sel_hi:[1,0]
    v_pk_mul_f32 v[42:43], v[42:43], v[46:47] op_sel_hi:[1,0]
    v_cvt_pk_bf16_f32 v0, v32, v33
    v_cvt_pk_bf16_f32 v1, v34, v35
    v_cvt_pk_bf16_f32 v2, v36, v37
    v_cvt_pk_bf16_f32 v3, v38, v39
    v_cvt_pk_bf16_f32 v4, v40, v41
    v_cvt_pk_bf16_f32 v5, v42, v43
    s_cbranch_scc1 L_fs_89
    buffer_store_dwordx4 v[0:3], v225, s[40:43], 0 offen
    buffer_store_dwordx2 v[4:5], v226, s[40:43], 0 offen
    s_branch L_fs_90
L_fs_89:
    buffer_store_dwordx4 v[0:3], v225, s[40:43], 0 offen sc1
    buffer_store_dwordx2 v[4:5], v226, s[40:43], 0 offen sc1
L_fs_90:
    v_mov_b32 v60, v56
    v_mov_b32 v61, v56
    s_nop 1
    v_permlane32_swap_b32 v61, v60
    s_cmp_eq_u32 s34, 0
    v_rcp_f32 v62, v60
    s_nop 0
    v_pk_mul_f32 v[48:49], v[48:49], v[62:63] op_sel_hi:[1,0]
    v_pk_mul_f32 v[50:51], v[50:51], v[62:63] op_sel_hi:[1,0]
    v_pk_mul_f32 v[52:53], v[52:53], v[62:63] op_sel_hi:[1,0]
    v_pk_mul_f32 v[54:55], v[54:55], v[62:63] op_sel_hi:[1,0]
    v_pk_mul_f32 v[56:57], v[56:57], v[62:63] op_sel_hi:[1,0]
    v_pk_mul_f32 v[58:59], v[58:59], v[62:63] op_sel_hi:[1,0]
    v_cvt_pk_bf16_f32 v16, v48, v49
    v_cvt_pk_bf16_f32 v17, v50, v51
    v_cvt_pk_bf16_f32 v18, v52, v53
    v_cvt_pk_bf16_f32 v19, v54, v55
    v_cvt_pk_bf16_f32 v20, v56, v57
    v_cvt_pk_bf16_f32 v21, v58, v59
    s_cbranch_scc1 L_fs_91
    buffer_store_dwordx4 v[16:19], v225, s[40:43], s51 offen
    buffer_store_dwordx2 v[20:21], v226, s[40:43], s51 offen
    s_branch L_fs_92
L_fs_91:
    buffer_store_dwordx4 v[16:19], v225, s[40:43], s51 offen sc1
    buffer_store_dwordx2 v[20:21], v226, s[40:43], s51 offen sc1
L_fs_92:
    s_branch L_ok_42
Lcode_end:
.section .rodata,"a"
.p2align 6
.amdhsa_kernel concat_heads__mha_block__softmax_full_mha__prompt_kernel
  .amdhsa_next_free_vgpr 256
  .amdhsa_next_free_sgpr 64
  .amdhsa_accum_offset 256
  .amdhsa_group_segment_fixed_size 0
  .amdhsa_kernarg_size 72
  .amdhsa_user_sgpr_count 2
  .amdhsa_user_sgpr_kernarg_segment_ptr 1
  .amdhsa_system_sgpr_workgroup_id_x 1
.end_amdhsa_kernel
```
